```python
import torch

def _softmax(x, axis=-1):
    return torch.softmax(x, dim=axis)

def _gelu(x):
    return torch.nn.functional.gelu(x, approximate='tanh')

def _silu(x):
    return torch.nn.functional.silu(x)

def _sigmoid(x):
    return torch.sigmoid(x)

def _layernorm(x, axis=-1, eps=1e-05):
    m = x.mean(dim=axis, keepdim=True)
    v = x.var(dim=axis, keepdim=True, unbiased=False)
    return (x - m) / torch.sqrt(v + eps)

def _scatter_add(tgt, idx, src, axis=0):
    return tgt.clone().index_add_(axis, idx, src)

def _segment_sum(src, seg, n):
    out = torch.zeros((n,) + src.shape[1:], dtype=src.dtype)
    return out.index_add_(0, seg, src)

def _pad(x, pw):
    flat = tuple((v for pair in reversed(pw) for v in pair))
    return torch.nn.functional.pad(x, flat)
kernel_name = 'recurrent_scan__linear_attn_block__mixer_gmlp__prompt'

def setup_inputs():

    _w = lambda a: (lambda t: t.to(torch.bfloat16) if t.is_floating_point() else t)(torch.as_tensor(a))

    def _A_setup():
        B, S, D = (1, 2048, 512)
        return {'x': _w((lambda *s: torch.randn(*s, dtype=torch.bfloat16) * 0.05)(B, S, D)), 'wqkv': _w((lambda *s: torch.randn(*s, dtype=torch.bfloat16) * 0.05)(D, 3 * D)), 'wo': _w((lambda *s: torch.randn(*s, dtype=torch.bfloat16) * 0.05)(D, D))}
    _A_in = _A_setup()

    def _B_setup():
        B, S, D, F = (1, 2048, 512, 1792)
        Fh = F // 2
        return {'x': _w((lambda *s: torch.randn(*s, dtype=torch.bfloat16) * 0.05)(B, S, D)), 'w_in': _w((lambda *s: torch.randn(*s, dtype=torch.bfloat16) * 0.8)(D, 2 * Fh)), 'w_sp': _w(0.01 * (lambda *s: torch.randn(*s, dtype=torch.bfloat16) * 0.8)(S, S)), 'b_sp': _w(1.0 + 0.01 * (lambda *s: torch.randn(*s, dtype=torch.bfloat16) * 0.05)(S)), 'w_out': _w((lambda *s: torch.randn(*s, dtype=torch.bfloat16) * 0.05)(Fh, D))}
    _B_in = _B_setup()
    return {'A_x': _A_in['x'], 'A_wqkv': _A_in['wqkv'], 'A_wo': _A_in['wo'], 'B_x': _B_in['x'], 'B_w_in': _B_in['w_in'], 'B_w_sp': _B_in['w_sp'], 'B_b_sp': _B_in['b_sp'], 'B_w_out': _B_in['w_out']}

def reference(A_x, A_wqkv, A_wo, B_x, B_w_in, B_w_sp, B_b_sp, B_w_out):

    def _A_ref(x, wqkv, wo):
        B, S, D = x.shape
        H = 32
        Dh = D // H
        qkv = (lambda x, *d: x.permute(*d))((x @ wqkv).reshape(B, S, 3, H, Dh), 2, 0, 3, 1, 4)
        q, k, v = (qkv[0], qkv[1], qkv[2])
        phi = lambda t: torch.where(t > 0, t + 1, torch.exp(t)) + 1e-06
        pq, pk = (phi(q), phi(k))
        kv = torch.einsum('bhsd,bhse->bhde', pk, v)
        z = torch.einsum('bhsd->bhd', pk)
        num = torch.einsum('bhqd,bhde->bhqe', pq, kv)
        den = torch.einsum('bhqd,bhd->bhq', pq, z)[..., None] + 1e-06
        o = num / den
        return (lambda x, *d: x.permute(*d))(o, 0, 2, 1, 3).reshape(B, S, D) @ wo

    def _B_ref(x, w_in, w_sp, b_sp, w_out):
        B, S, D = x.shape
        F = w_in.shape[-1]
        Fh = F // 2
        z = _gelu(torch.einsum('bsd,df->bsf', x, w_in))
        z1 = z[..., :Fh].clone()
        z2 = _layernorm(z[..., Fh:], axis=-1)
        g = torch.einsum('ts,bsf->btf', w_sp, z2) + b_sp[None, :, None]
        return torch.einsum('bsf,fd->bsd', z1 * g, w_out)
    x = A_x
    xn = _layernorm(x, axis=-1)
    s = _A_ref(xn, A_wqkv, A_wo)
    g = _silu(_B_ref(xn, B_w_in, B_w_sp, B_b_sp, B_w_out))
    return x + s * g
```

```asm
; @launch grid=(256,1,1) block=(256,1,1) lds=163840
.amdgcn_target "amdgcn-amd-amdhsa--gfx950"
.text
.globl recurrent_scan__linear_attn_block__mixer_gmlp__prompt_kernel
.p2align 8
.type recurrent_scan__linear_attn_block__mixer_gmlp__prompt_kernel,@function
recurrent_scan__linear_attn_block__mixer_gmlp__prompt_kernel:
    s_cmp_ge_u32 s2, 256
    s_cbranch_scc1 L_end
    s_load_dwordx16 s[64:79], s[0:1], 0
    s_load_dwordx4 s[80:83], s[0:1], 64
    s_load_dwordx2 s[84:85], s[0:1], 80
    v_and_b32 v1, 63, v0
    v_lshrrev_b32 v2, 6, v0
    s_nop 0
    v_readfirstlane_b32 s46, v2
    s_and_b32 s48, s2, 7
    s_lshr_b32 s49, s2, 3
    s_lshr_b32 s44, s48, 1
    s_lshl_b32 s44, s44, 3
    s_and_b32 s50, s49, 7
    s_add_u32 s44, s44, s50
    s_and_b32 s45, s48, 1
    s_lshl_b32 s45, s45, 2
    s_lshr_b32 s50, s49, 3
    s_add_u32 s45, s45, s50
    s_and_b32 s62, s46, 1
    s_lshr_b32 s63, s46, 1
    s_lshl_b32 s89, s45, 8
    s_cmp_eq_u32 s45, 7
    s_cselect_b32 s89, 0x7f000000, s89
    s_mov_b32 s56, 0xbdd2d3e8
    s_mov_b32 s57, 0x3fb8aa3b
    s_mov_b32 s58, 0x358637bd
    s_mov_b32 s60, 0xffff0000
    s_mov_b32 s61, 0xffff0000
    v_mov_b32 v17, 0xc0135761
    v_lshrrev_b32 v209, 3, v1
    v_and_b32 v210, 7, v1
    v_lshlrev_b32 v208, 10, v209
    v_lshl_add_u32 v208, v210, 4, v208
    s_and_b32 s4, s44, 3
    s_and_b32 s5, s45, 3
    s_lshl_b32 s5, s5, 1
    s_and_b32 s6, s44, 7
    s_xor_b32 s5, s5, s6
    s_and_b32 s5, s5, 0
    s_and_b32 s6, s45, 3
    s_lshl_b32 s48, s44, 16
    s_lshl_b32 s49, s46, 14
    s_add_u32 s7, s48, s49
    s_xor_b32 s48, s6, 0
    s_lshl_b32 s48, s48, 8
    s_add_u32 s48, s48, s7
    s_add_u32 s52, s48, 8192
    s_xor_b32 s49, s6, 1
    s_lshl_b32 s49, s49, 8
    s_add_u32 s49, s49, s7
    s_add_u32 s53, s49, 8192
    s_xor_b32 s50, s6, 2
    s_lshl_b32 s50, s50, 8
    s_add_u32 s50, s50, s7
    s_add_u32 s54, s50, 8192
    s_xor_b32 s51, s6, 3
    s_lshl_b32 s51, s51, 8
    s_add_u32 s51, s51, s7
    s_add_u32 s55, s51, 8192
    s_waitcnt lgkmcnt(0)
    s_mov_b32 s8, s64
    s_and_b32 s9, s65, 0xffff
    s_mov_b32 s10, 0x200000
    s_mov_b32 s11, 0x20000
    buffer_load_dwordx4 v[144:147], v208, s[8:11], s48 offen offset:0
    buffer_load_dwordx4 v[148:151], v208, s[8:11], s48 offen offset:128
    buffer_load_dwordx4 v[152:155], v208, s[8:11], s49 offen offset:0
    buffer_load_dwordx4 v[156:159], v208, s[8:11], s49 offen offset:128
    buffer_load_dwordx4 v[160:163], v208, s[8:11], s50 offen offset:0
    buffer_load_dwordx4 v[164:167], v208, s[8:11], s50 offen offset:128
    buffer_load_dwordx4 v[168:171], v208, s[8:11], s51 offen offset:0
    buffer_load_dwordx4 v[172:175], v208, s[8:11], s51 offen offset:128
    buffer_load_dwordx4 v[176:179], v208, s[8:11], s52 offen offset:0
    buffer_load_dwordx4 v[180:183], v208, s[8:11], s52 offen offset:128
    buffer_load_dwordx4 v[184:187], v208, s[8:11], s53 offen offset:0
    buffer_load_dwordx4 v[188:191], v208, s[8:11], s53 offen offset:128
    buffer_load_dwordx4 v[192:195], v208, s[8:11], s54 offen offset:0
    buffer_load_dwordx4 v[196:199], v208, s[8:11], s54 offen offset:128
    buffer_load_dwordx4 v[200:203], v208, s[8:11], s55 offen offset:0
    buffer_load_dwordx4 v[204:207], v208, s[8:11], s55 offen offset:128
    s_mov_b32 s16, s72
    s_and_b32 s17, s73, 0xffff
    s_mov_b32 s18, 0x1c0000
    s_mov_b32 s19, 0x20000
    s_mov_b32 s36, s84
    s_and_b32 s37, s85, 0xffff
    s_mov_b32 s38, 0xb00000
    s_mov_b32 s39, 0x20000
    s_mov_b32 s12, s66
    s_and_b32 s13, s67, 0xffff
    s_mov_b32 s14, 0x180000
    s_mov_b32 s15, 0x20000
    s_mov_b32 s24, s68
    s_and_b32 s25, s69, 0xffff
    s_mov_b32 s26, 0x80000
    s_mov_b32 s27, 0x20000
    s_mov_b32 s20, s74
    s_and_b32 s21, s75, 0xffff
    s_mov_b32 s22, 0x800000
    s_mov_b32 s23, 0x20000
    s_mov_b32 s40, s76
    s_and_b32 s41, s77, 0xffff
    s_mov_b32 s42, 0x1000
    s_mov_b32 s43, 0x20000
    s_mov_b32 s28, s78
    s_and_b32 s29, s79, 0xffff
    s_mov_b32 s30, 0xe0000
    s_mov_b32 s31, 0x20000
    s_mov_b32 s32, s80
    s_and_b32 s33, s81, 0xffff
    s_mov_b32 s34, 0x200000
    s_mov_b32 s35, 0x20000
    s_lshl_b32 s50, s46, 14
    v_xor_b32 v210, v210, v209
    v_lshlrev_b32 v211, 10, v209
    v_lshl_add_u32 v211, v210, 4, v211
    v_add_u32 v211, s50, v211
    s_xor_b32 s51, s6, 0
    s_lshl_b32 s51, s51, 8
    v_add_u32 v104, s51, v211
    s_xor_b32 s51, s6, 1
    s_lshl_b32 s51, s51, 8
    v_add_u32 v105, s51, v211
    s_xor_b32 s51, s6, 2
    s_lshl_b32 s51, s51, 8
    v_add_u32 v106, s51, v211
    s_xor_b32 s51, s6, 3
    s_lshl_b32 s51, s51, 8
    v_add_u32 v107, s51, v211
    s_xor_b32 s51, s4, 0
    s_lshl_b32 s51, s51, 7
    s_lshl_b32 s52, s46, 5
    s_add_u32 s51, s51, s52
    s_mul_i32 s64, s51, 3584
    s_add_u32 s64, s64, s89
    s_mul_i32 s68, s51, 3072
    s_lshl_b32 s52, s45, 7
    s_add_u32 s68, s68, s52
    s_xor_b32 s51, s4, 1
    s_lshl_b32 s51, s51, 7
    s_lshl_b32 s52, s46, 5
    s_add_u32 s51, s51, s52
    s_mul_i32 s65, s51, 3584
    s_add_u32 s65, s65, s89
    s_mul_i32 s69, s51, 3072
    s_lshl_b32 s52, s45, 7
    s_add_u32 s69, s69, s52
    s_xor_b32 s51, s4, 2
    s_lshl_b32 s51, s51, 7
    s_lshl_b32 s52, s46, 5
    s_add_u32 s51, s51, s52
    s_mul_i32 s66, s51, 3584
    s_add_u32 s66, s66, s89
    s_mul_i32 s70, s51, 3072
    s_lshl_b32 s52, s45, 7
    s_add_u32 s70, s70, s52
    s_xor_b32 s51, s4, 3
    s_lshl_b32 s51, s51, 7
    s_lshl_b32 s52, s46, 5
    s_add_u32 s51, s51, s52
    s_mul_i32 s67, s51, 3584
    s_add_u32 s67, s67, s89
    s_mul_i32 s71, s51, 3072
    s_lshl_b32 s52, s45, 7
    s_add_u32 s71, s71, s52
    s_lshl_b32 s72, s46, 12
    s_lshl_b32 s74, s44, 18
    s_lshl_b32 s51, s46, 7
    s_add_u32 s74, s74, s51
    s_cmp_eq_u32 s45, 7
    s_cselect_b32 s74, 0x7f000000, s74
    v_lshrrev_b32 v246, 3, v1
    v_and_b32 v247, 7, v1
    v_bfe_u32 v248, v1, 4, 1
    v_lshlrev_b32 v248, 2, v248
    v_xor_b32 v247, v247, v248
    v_mul_u32_u24 v248, 3584, v246
    v_lshl_add_u32 v2, v247, 4, v248
    v_add_u32 v3, 27648, v2
    v_add_u32 v4, 55296, v2
    v_add_u32 v5, 82944, v2
    v_mul_u32_u24 v248, 3072, v246
    v_lshl_add_u32 v9, v247, 4, v248
    v_add_u32 v10, 23552, v9
    v_add_u32 v11, 47104, v9
    v_add_u32 v12, 70656, v9
    s_lshr_b32 s96, s2, 3
    s_lshl_b32 s97, s46, 5
    s_add_u32 s96, s96, s97
    s_cmp_ge_u32 s96, 5
    s_cbranch_scc1 L_ct_1
    s_getpc_b64 s[98:99]
    s_lshl_b32 s96, s96, 13
    v_lshlrev_b32 v234, 7, v1
    v_add_u32 v234, s96, v234
    v_min_u32 v234, 35872, v234
    global_load_dword v0, v234, s[98:99]
L_ct_1:
    v_mov_b32 v246, 0
    buffer_load_dword v247, v246, s[36:39], 0 offen sc1
    v_mov_b32 v248, 0
    v_mov_b32 v249, 0
    v_mov_b32 v250, 0
    v_mov_b32 v251, 0
    s_lshl_b32 s52, s45, 12
    s_lshl_b32 s53, s46, 10
    s_add_u32 s52, s52, s53
    s_add_u32 s52, s52, 131072
    s_cmp_eq_u32 s44, 0
    s_cselect_b32 s52, s52, 0x7f000000
    v_lshlrev_b32 v252, 4, v1
    buffer_store_dwordx4 v[248:251], v252, s[36:39], s52 offen sc1
    s_lshl_b32 s53, s45, 8
    s_add_u32 s53, s53, 163840
    s_or_b32 s54, s44, s46
    s_cmp_eq_u32 s54, 0
    s_cselect_b32 s53, s53, 0x7f000000
    s_mov_b64 exec, 0xffff
    buffer_store_dwordx4 v[248:251], v252, s[36:39], s53 offen sc1
    s_mov_b64 exec, -1
    v_lshrrev_b32 v240, 5, v1
    v_bfe_u32 v241, v1, 2, 2
    v_bfe_u32 v243, v1, 4, 1
    v_and_b32 v244, 3, v1
    v_lshl_add_u32 v242, v240, 3, v241
    v_lshlrev_b32 v242, 7, v242
    v_lshl_add_u32 v242, v243, 5, v242
    v_lshl_add_u32 v242, v244, 3, v242
    v_lshrrev_b32 v241, 1, v241
    v_xor_b32 v243, s63, v241
    v_lshl_add_u32 v14, v243, 6, v242
    v_xor_b32 v243, s62, v241
    v_lshl_add_u32 v13, v243, 6, v242
    s_lshl_b32 s52, s63, 14
    v_add_u32 v13, s52, v13
    v_and_b32 v240, 0x13, v1
    v_bfe_u32 v241, v1, 2, 1
    v_lshl_or_b32 v240, v241, 3, v240
    v_bfe_u32 v241, v1, 3, 1
    v_lshl_or_b32 v240, v241, 2, v240
    v_and_b32 v241, 15, v240
    v_lshrrev_b32 v242, 5, v1
    v_xor_b32 v241, v241, v242
    v_lshlrev_b32 v240, 10, v240
    s_lshl_b32 s52, s62, 15
    s_lshl_b32 s53, s4, 8
    s_add_u32 s52, s52, s53
    s_xor_b32 s53, s52, 32768
    v_xor_b32 v242, 0, v241
    v_lshl_add_u32 v242, v242, 4, v240
    v_add_u32 v128, s52, v242
    v_add_u32 v136, s53, v242
    v_xor_b32 v242, 2, v241
    v_lshl_add_u32 v242, v242, 4, v240
    v_add_u32 v129, s52, v242
    v_add_u32 v137, s53, v242
    v_xor_b32 v242, 4, v241
    v_lshl_add_u32 v242, v242, 4, v240
    v_add_u32 v130, s52, v242
    v_add_u32 v138, s53, v242
    v_xor_b32 v242, 6, v241
    v_lshl_add_u32 v242, v242, 4, v240
    v_add_u32 v131, s52, v242
    v_add_u32 v139, s53, v242
    v_xor_b32 v242, 8, v241
    v_lshl_add_u32 v242, v242, 4, v240
    v_add_u32 v132, s52, v242
    v_add_u32 v140, s53, v242
    v_xor_b32 v242, 10, v241
    v_lshl_add_u32 v242, v242, 4, v240
    v_add_u32 v133, s52, v242
    v_add_u32 v141, s53, v242
    v_xor_b32 v242, 12, v241
    v_lshl_add_u32 v242, v242, 4, v240
    v_add_u32 v134, s52, v242
    v_add_u32 v142, s53, v242
    v_xor_b32 v242, 14, v241
    v_lshl_add_u32 v242, v242, 4, v240
    v_add_u32 v135, s52, v242
    v_add_u32 v143, s53, v242
    v_mov_b32 v212, 0x3f803f80
    v_mov_b32 v214, 0
    v_mov_b32 v215, 0
    v_mov_b32 v216, 0
    v_mov_b32 v217, 0
    v_mov_b32 v218, 0
    v_mov_b32 v219, 0
    v_mov_b32 v220, 0
    v_mov_b32 v221, 0
    s_waitcnt vmcnt(18)
    v_dot2_f32_bf16 v214, v144, v212, v214
    v_dot2_f32_bf16 v218, v144, v144, v218
    v_dot2_f32_bf16 v215, v145, v212, v215
    v_dot2_f32_bf16 v219, v145, v145, v219
    v_dot2_f32_bf16 v214, v146, v212, v214
    v_dot2_f32_bf16 v218, v146, v146, v218
    v_dot2_f32_bf16 v215, v147, v212, v215
    s_add_u32 s92, s64, 1792
    s_add_u32 m0, s72, 65536
    s_nop 0
    buffer_load_dwordx4 v2, s[16:19], s92 offen offset:0 lds
    v_dot2_f32_bf16 v219, v147, v147, v219
    s_waitcnt vmcnt(18)
    v_dot2_f32_bf16 v214, v148, v212, v214
    v_dot2_f32_bf16 v218, v148, v148, v218
    v_dot2_f32_bf16 v215, v149, v212, v215
    v_dot2_f32_bf16 v219, v149, v149, v219
    v_dot2_f32_bf16 v214, v150, v212, v214
    v_dot2_f32_bf16 v218, v150, v150, v218
    v_dot2_f32_bf16 v215, v151, v212, v215
    v_dot2_f32_bf16 v219, v151, v151, v219
    s_waitcnt vmcnt(17)
    v_dot2_f32_bf16 v214, v152, v212, v214
    v_dot2_f32_bf16 v218, v152, v152, v218
    v_dot2_f32_bf16 v215, v153, v212, v215
    v_dot2_f32_bf16 v219, v153, v153, v219
    v_dot2_f32_bf16 v214, v154, v212, v214
    v_dot2_f32_bf16 v218, v154, v154, v218
    buffer_load_dwordx4 v3, s[16:19], s92 offen offset:1024 lds
    v_dot2_f32_bf16 v215, v155, v212, v215
    v_dot2_f32_bf16 v219, v155, v155, v219
    s_waitcnt vmcnt(17)
    v_dot2_f32_bf16 v214, v156, v212, v214
    v_dot2_f32_bf16 v218, v156, v156, v218
    v_dot2_f32_bf16 v215, v157, v212, v215
    v_dot2_f32_bf16 v219, v157, v157, v219
    v_dot2_f32_bf16 v214, v158, v212, v214
    v_dot2_f32_bf16 v218, v158, v158, v218
    v_dot2_f32_bf16 v215, v159, v212, v215
    v_dot2_f32_bf16 v219, v159, v159, v219
    s_waitcnt vmcnt(16)
    v_dot2_f32_bf16 v214, v160, v212, v214
    v_dot2_f32_bf16 v218, v160, v160, v218
    v_dot2_f32_bf16 v215, v161, v212, v215
    v_dot2_f32_bf16 v219, v161, v161, v219
    v_dot2_f32_bf16 v214, v162, v212, v214
    buffer_load_dwordx4 v4, s[16:19], s92 offen offset:2048 lds
    v_dot2_f32_bf16 v218, v162, v162, v218
    v_dot2_f32_bf16 v215, v163, v212, v215
    v_dot2_f32_bf16 v219, v163, v163, v219
    s_waitcnt vmcnt(16)
    v_dot2_f32_bf16 v214, v164, v212, v214
    v_dot2_f32_bf16 v218, v164, v164, v218
    v_dot2_f32_bf16 v215, v165, v212, v215
    v_dot2_f32_bf16 v219, v165, v165, v219
    v_dot2_f32_bf16 v214, v166, v212, v214
    v_dot2_f32_bf16 v218, v166, v166, v218
    v_dot2_f32_bf16 v215, v167, v212, v215
    v_dot2_f32_bf16 v219, v167, v167, v219
    s_waitcnt vmcnt(15)
    v_dot2_f32_bf16 v214, v168, v212, v214
    v_dot2_f32_bf16 v218, v168, v168, v218
    v_dot2_f32_bf16 v215, v169, v212, v215
    v_dot2_f32_bf16 v219, v169, v169, v219
    buffer_load_dwordx4 v5, s[16:19], s92 offen offset:3072 lds
    v_dot2_f32_bf16 v214, v170, v212, v214
    v_dot2_f32_bf16 v218, v170, v170, v218
    v_dot2_f32_bf16 v215, v171, v212, v215
    v_dot2_f32_bf16 v219, v171, v171, v219
    s_waitcnt vmcnt(15)
    v_dot2_f32_bf16 v214, v172, v212, v214
    v_dot2_f32_bf16 v218, v172, v172, v218
    v_dot2_f32_bf16 v215, v173, v212, v215
    v_dot2_f32_bf16 v219, v173, v173, v219
    v_dot2_f32_bf16 v214, v174, v212, v214
    v_dot2_f32_bf16 v218, v174, v174, v218
    v_dot2_f32_bf16 v215, v175, v212, v215
    v_dot2_f32_bf16 v219, v175, v175, v219
    s_waitcnt vmcnt(14)
    v_dot2_f32_bf16 v216, v176, v212, v216
    v_dot2_f32_bf16 v220, v176, v176, v220
    v_dot2_f32_bf16 v217, v177, v212, v217
    s_add_u32 s92, s64, 1920
    s_add_u32 m0, s72, 81920
    s_nop 0
    buffer_load_dwordx4 v2, s[16:19], s92 offen offset:0 lds
    v_dot2_f32_bf16 v221, v177, v177, v221
    v_dot2_f32_bf16 v216, v178, v212, v216
    v_dot2_f32_bf16 v220, v178, v178, v220
    v_dot2_f32_bf16 v217, v179, v212, v217
    v_dot2_f32_bf16 v221, v179, v179, v221
    s_waitcnt vmcnt(14)
    v_dot2_f32_bf16 v216, v180, v212, v216
    v_dot2_f32_bf16 v220, v180, v180, v220
    v_dot2_f32_bf16 v217, v181, v212, v217
    v_dot2_f32_bf16 v221, v181, v181, v221
    v_dot2_f32_bf16 v216, v182, v212, v216
    v_dot2_f32_bf16 v220, v182, v182, v220
    v_dot2_f32_bf16 v217, v183, v212, v217
    v_dot2_f32_bf16 v221, v183, v183, v221
    s_waitcnt vmcnt(13)
    v_dot2_f32_bf16 v216, v184, v212, v216
    v_dot2_f32_bf16 v220, v184, v184, v220
    buffer_load_dwordx4 v3, s[16:19], s92 offen offset:1024 lds
    v_dot2_f32_bf16 v217, v185, v212, v217
    v_dot2_f32_bf16 v221, v185, v185, v221
    v_dot2_f32_bf16 v216, v186, v212, v216
    v_dot2_f32_bf16 v220, v186, v186, v220
    v_dot2_f32_bf16 v217, v187, v212, v217
    v_dot2_f32_bf16 v221, v187, v187, v221
    s_waitcnt vmcnt(13)
    v_dot2_f32_bf16 v216, v188, v212, v216
    v_dot2_f32_bf16 v220, v188, v188, v220
    v_dot2_f32_bf16 v217, v189, v212, v217
    v_dot2_f32_bf16 v221, v189, v189, v221
    v_dot2_f32_bf16 v216, v190, v212, v216
    v_dot2_f32_bf16 v220, v190, v190, v220
    v_dot2_f32_bf16 v217, v191, v212, v217
    v_dot2_f32_bf16 v221, v191, v191, v221
    s_waitcnt vmcnt(12)
    buffer_load_dwordx4 v4, s[16:19], s92 offen offset:2048 lds
    v_dot2_f32_bf16 v216, v192, v212, v216
    v_dot2_f32_bf16 v220, v192, v192, v220
    v_dot2_f32_bf16 v217, v193, v212, v217
    v_dot2_f32_bf16 v221, v193, v193, v221
    v_dot2_f32_bf16 v216, v194, v212, v216
    v_dot2_f32_bf16 v220, v194, v194, v220
    v_dot2_f32_bf16 v217, v195, v212, v217
    v_dot2_f32_bf16 v221, v195, v195, v221
    s_waitcnt vmcnt(12)
    v_dot2_f32_bf16 v216, v196, v212, v216
    v_dot2_f32_bf16 v220, v196, v196, v220
    v_dot2_f32_bf16 v217, v197, v212, v217
    v_dot2_f32_bf16 v221, v197, v197, v221
    v_dot2_f32_bf16 v216, v198, v212, v216
    v_dot2_f32_bf16 v220, v198, v198, v220
    v_dot2_f32_bf16 v217, v199, v212, v217
    v_dot2_f32_bf16 v221, v199, v199, v221
    buffer_load_dwordx4 v5, s[16:19], s92 offen offset:3072 lds
    s_waitcnt vmcnt(12)
    v_dot2_f32_bf16 v216, v200, v212, v216
    v_dot2_f32_bf16 v220, v200, v200, v220
    v_dot2_f32_bf16 v217, v201, v212, v217
    v_dot2_f32_bf16 v221, v201, v201, v221
    v_dot2_f32_bf16 v216, v202, v212, v216
    v_dot2_f32_bf16 v220, v202, v202, v220
    v_dot2_f32_bf16 v217, v203, v212, v217
    v_dot2_f32_bf16 v221, v203, v203, v221
    s_waitcnt vmcnt(11)
    v_dot2_f32_bf16 v216, v204, v212, v216
    v_dot2_f32_bf16 v220, v204, v204, v220
    v_dot2_f32_bf16 v217, v205, v212, v217
    v_dot2_f32_bf16 v221, v205, v205, v221
    v_dot2_f32_bf16 v216, v206, v212, v216
    v_dot2_f32_bf16 v220, v206, v206, v220
    v_dot2_f32_bf16 v217, v207, v212, v217
    v_lshlrev_b32 v102, 7, v1
    s_mul_i32 s52, s2, 6144
    s_cmp_eq_u32 s46, 0
    s_cselect_b32 s52, s52, 0x7f000000
    buffer_load_dword v0, v102, s[12:15], s52 offen
    v_dot2_f32_bf16 v221, v207, v207, v221
    v_add_f32 v214, v214, v215
    v_add_f32 v218, v218, v219
    v_add_f32 v216, v216, v217
    v_add_f32 v220, v220, v221
    v_add_f32_dpp v214, v214, v214 quad_perm:[1,0,3,2] row_mask:0xf bank_mask:0xf
    v_add_f32_dpp v218, v218, v218 quad_perm:[1,0,3,2] row_mask:0xf bank_mask:0xf
    v_add_f32_dpp v216, v216, v216 quad_perm:[1,0,3,2] row_mask:0xf bank_mask:0xf
    v_add_f32_dpp v220, v220, v220 quad_perm:[1,0,3,2] row_mask:0xf bank_mask:0xf
    v_add_f32_dpp v214, v214, v214 quad_perm:[2,3,0,1] row_mask:0xf bank_mask:0xf
    v_add_f32_dpp v218, v218, v218 quad_perm:[2,3,0,1] row_mask:0xf bank_mask:0xf
    v_add_f32_dpp v216, v216, v216 quad_perm:[2,3,0,1] row_mask:0xf bank_mask:0xf
    v_add_f32_dpp v220, v220, v220 quad_perm:[2,3,0,1] row_mask:0xf bank_mask:0xf
    v_add_f32_dpp v214, v214, v214 row_half_mirror row_mask:0xf bank_mask:0xf
    v_add_f32_dpp v218, v218, v218 row_half_mirror row_mask:0xf bank_mask:0xf
    v_add_f32_dpp v216, v216, v216 row_half_mirror row_mask:0xf bank_mask:0xf
    v_add_f32_dpp v220, v220, v220 row_half_mirror row_mask:0xf bank_mask:0xf
    s_mul_i32 s52, s2, 7168
    s_cmp_eq_u32 s46, 1
    s_cselect_b32 s52, s52, 0x7f000000
    buffer_load_dword v0, v102, s[16:19], s52 offen
    v_mul_f32 v214, 0x3b000000, v214
    v_mul_f32 v218, 0x3b000000, v218
    v_mul_f32 v216, 0x3b000000, v216
    v_mul_f32 v220, 0x3b000000, v220
    v_fma_f32 v218, -v214, v214, v218
    v_fma_f32 v220, -v216, v216, v220
    v_max_f32 v218, 0, v218
    v_add_f32 v218, 0x3727c5ac, v218
    v_max_f32 v220, 0, v220
    v_add_f32 v220, 0x3727c5ac, v220
    v_rsq_f32 v222, v218
    v_rsq_f32 v224, v220
    v_mul_f32 v223, -v214, v222
    v_mul_f32 v225, -v216, v224
    v_lshlrev_b32 v226, 16, v144
    v_and_b32 v227, 0xffff0000, v144
    v_lshlrev_b32 v228, 16, v145
    s_mul_i32 s52, s2, 3584
    s_cmp_eq_u32 s46, 2
    s_cselect_b32 s52, s52, 0x7f000000
    s_mov_b32 exec_hi, 0
    buffer_load_dword v0, v102, s[28:31], s52 offen
    s_lshl_b32 s52, s2, 11
    s_cmp_eq_u32 s46, 3
    s_cselect_b32 s52, s52, 0x7f000000
    s_mov_b32 exec_lo, 0xffff
    buffer_load_dword v0, v102, s[24:27], s52 offen
    s_mov_b64 exec, -1
    v_and_b32 v229, 0xffff0000, v145
    v_lshlrev_b32 v230, 16, v146
    v_and_b32 v231, 0xffff0000, v146
    v_lshlrev_b32 v232, 16, v147
    v_and_b32 v233, 0xffff0000, v147
    v_pk_fma_f32 v[226:227], v[226:227], v[222:223], v[222:223] op_sel:[0,0,1] op_sel_hi:[1,0,1]
    v_pk_fma_f32 v[228:229], v[228:229], v[222:223], v[222:223] op_sel:[0,0,1] op_sel_hi:[1,0,1]
    v_pk_fma_f32 v[230:231], v[230:231], v[222:223], v[222:223] op_sel:[0,0,1] op_sel_hi:[1,0,1]
    v_pk_fma_f32 v[232:233], v[232:233], v[222:223], v[222:223] op_sel:[0,0,1] op_sel_hi:[1,0,1]
    v_cvt_pk_bf16_f32 v144, v226, v227
    v_cvt_pk_bf16_f32 v145, v228, v229
    v_cvt_pk_bf16_f32 v146, v230, v231
    v_cvt_pk_bf16_f32 v147, v232, v233
    ds_write_b128 v104, v[144:147] offset:0
    v_lshlrev_b32 v226, 16, v148
    v_and_b32 v227, 0xffff0000, v148
    v_lshlrev_b32 v228, 16, v149
    s_add_u32 s92, s65, 1792
    s_add_u32 m0, s72, 98304
    s_nop 0
    buffer_load_dwordx4 v2, s[16:19], s92 offen offset:0 lds
    v_and_b32 v229, 0xffff0000, v149
    v_lshlrev_b32 v230, 16, v150
    v_and_b32 v231, 0xffff0000, v150
    v_lshlrev_b32 v232, 16, v151
    v_and_b32 v233, 0xffff0000, v151
    v_pk_fma_f32 v[226:227], v[226:227], v[222:223], v[222:223] op_sel:[0,0,1] op_sel_hi:[1,0,1]
    v_pk_fma_f32 v[228:229], v[228:229], v[222:223], v[222:223] op_sel:[0,0,1] op_sel_hi:[1,0,1]
    v_pk_fma_f32 v[230:231], v[230:231], v[222:223], v[222:223] op_sel:[0,0,1] op_sel_hi:[1,0,1]
    v_pk_fma_f32 v[232:233], v[232:233], v[222:223], v[222:223] op_sel:[0,0,1] op_sel_hi:[1,0,1]
    v_cvt_pk_bf16_f32 v148, v226, v227
    v_cvt_pk_bf16_f32 v149, v228, v229
    v_cvt_pk_bf16_f32 v150, v230, v231
    v_cvt_pk_bf16_f32 v151, v232, v233
    ds_write_b128 v104, v[148:151] offset:128
    v_lshlrev_b32 v226, 16, v152
    v_and_b32 v227, 0xffff0000, v152
    v_lshlrev_b32 v228, 16, v153
    buffer_load_dwordx4 v3, s[16:19], s92 offen offset:1024 lds
    v_and_b32 v229, 0xffff0000, v153
    v_lshlrev_b32 v230, 16, v154
    v_and_b32 v231, 0xffff0000, v154
    v_lshlrev_b32 v232, 16, v155
    v_and_b32 v233, 0xffff0000, v155
    v_pk_fma_f32 v[226:227], v[226:227], v[222:223], v[222:223] op_sel:[0,0,1] op_sel_hi:[1,0,1]
    v_pk_fma_f32 v[228:229], v[228:229], v[222:223], v[222:223] op_sel:[0,0,1] op_sel_hi:[1,0,1]
    v_pk_fma_f32 v[230:231], v[230:231], v[222:223], v[222:223] op_sel:[0,0,1] op_sel_hi:[1,0,1]
    v_pk_fma_f32 v[232:233], v[232:233], v[222:223], v[222:223] op_sel:[0,0,1] op_sel_hi:[1,0,1]
    v_cvt_pk_bf16_f32 v152, v226, v227
    v_cvt_pk_bf16_f32 v153, v228, v229
    v_cvt_pk_bf16_f32 v154, v230, v231
    v_cvt_pk_bf16_f32 v155, v232, v233
    ds_write_b128 v105, v[152:155] offset:0
    v_lshlrev_b32 v226, 16, v156
    v_and_b32 v227, 0xffff0000, v156
    buffer_load_dwordx4 v4, s[16:19], s92 offen offset:2048 lds
    v_lshlrev_b32 v228, 16, v157
    v_and_b32 v229, 0xffff0000, v157
    v_lshlrev_b32 v230, 16, v158
    v_and_b32 v231, 0xffff0000, v158
    v_lshlrev_b32 v232, 16, v159
    v_and_b32 v233, 0xffff0000, v159
    v_pk_fma_f32 v[226:227], v[226:227], v[222:223], v[222:223] op_sel:[0,0,1] op_sel_hi:[1,0,1]
    v_pk_fma_f32 v[228:229], v[228:229], v[222:223], v[222:223] op_sel:[0,0,1] op_sel_hi:[1,0,1]
    v_pk_fma_f32 v[230:231], v[230:231], v[222:223], v[222:223] op_sel:[0,0,1] op_sel_hi:[1,0,1]
    v_pk_fma_f32 v[232:233], v[232:233], v[222:223], v[222:223] op_sel:[0,0,1] op_sel_hi:[1,0,1]
    v_cvt_pk_bf16_f32 v156, v226, v227
    v_cvt_pk_bf16_f32 v157, v228, v229
    v_cvt_pk_bf16_f32 v158, v230, v231
    v_cvt_pk_bf16_f32 v159, v232, v233
    ds_write_b128 v105, v[156:159] offset:128
    v_lshlrev_b32 v226, 16, v160
    v_and_b32 v227, 0xffff0000, v160
    buffer_load_dwordx4 v5, s[16:19], s92 offen offset:3072 lds
    v_lshlrev_b32 v228, 16, v161
    v_and_b32 v229, 0xffff0000, v161
    v_lshlrev_b32 v230, 16, v162
    v_and_b32 v231, 0xffff0000, v162
    v_lshlrev_b32 v232, 16, v163
    v_and_b32 v233, 0xffff0000, v163
    v_pk_fma_f32 v[226:227], v[226:227], v[222:223], v[222:223] op_sel:[0,0,1] op_sel_hi:[1,0,1]
    v_pk_fma_f32 v[228:229], v[228:229], v[222:223], v[222:223] op_sel:[0,0,1] op_sel_hi:[1,0,1]
    v_pk_fma_f32 v[230:231], v[230:231], v[222:223], v[222:223] op_sel:[0,0,1] op_sel_hi:[1,0,1]
    v_pk_fma_f32 v[232:233], v[232:233], v[222:223], v[222:223] op_sel:[0,0,1] op_sel_hi:[1,0,1]
    v_cvt_pk_bf16_f32 v160, v226, v227
    v_cvt_pk_bf16_f32 v161, v228, v229
    v_cvt_pk_bf16_f32 v162, v230, v231
    v_cvt_pk_bf16_f32 v163, v232, v233
    ds_write_b128 v106, v[160:163] offset:0
    v_lshlrev_b32 v226, 16, v164
    v_and_b32 v227, 0xffff0000, v164
    s_add_u32 s92, s65, 1920
    s_add_u32 m0, s72, 114688
    s_nop 0
    buffer_load_dwordx4 v2, s[16:19], s92 offen offset:0 lds
    v_lshlrev_b32 v228, 16, v165
    v_and_b32 v229, 0xffff0000, v165
    v_lshlrev_b32 v230, 16, v166
    v_and_b32 v231, 0xffff0000, v166
    v_lshlrev_b32 v232, 16, v167
    v_and_b32 v233, 0xffff0000, v167
    v_pk_fma_f32 v[226:227], v[226:227], v[222:223], v[222:223] op_sel:[0,0,1] op_sel_hi:[1,0,1]
    v_pk_fma_f32 v[228:229], v[228:229], v[222:223], v[222:223] op_sel:[0,0,1] op_sel_hi:[1,0,1]
    v_pk_fma_f32 v[230:231], v[230:231], v[222:223], v[222:223] op_sel:[0,0,1] op_sel_hi:[1,0,1]
    v_pk_fma_f32 v[232:233], v[232:233], v[222:223], v[222:223] op_sel:[0,0,1] op_sel_hi:[1,0,1]
    v_cvt_pk_bf16_f32 v164, v226, v227
    v_cvt_pk_bf16_f32 v165, v228, v229
    v_cvt_pk_bf16_f32 v166, v230, v231
    v_cvt_pk_bf16_f32 v167, v232, v233
    ds_write_b128 v106, v[164:167] offset:128
    v_lshlrev_b32 v226, 16, v168
    v_and_b32 v227, 0xffff0000, v168
    buffer_load_dwordx4 v3, s[16:19], s92 offen offset:1024 lds
    v_lshlrev_b32 v228, 16, v169
    v_and_b32 v229, 0xffff0000, v169
    v_lshlrev_b32 v230, 16, v170
    v_and_b32 v231, 0xffff0000, v170
    v_lshlrev_b32 v232, 16, v171
    v_and_b32 v233, 0xffff0000, v171
    v_pk_fma_f32 v[226:227], v[226:227], v[222:223], v[222:223] op_sel:[0,0,1] op_sel_hi:[1,0,1]
    v_pk_fma_f32 v[228:229], v[228:229], v[222:223], v[222:223] op_sel:[0,0,1] op_sel_hi:[1,0,1]
    v_pk_fma_f32 v[230:231], v[230:231], v[222:223], v[222:223] op_sel:[0,0,1] op_sel_hi:[1,0,1]
    v_pk_fma_f32 v[232:233], v[232:233], v[222:223], v[222:223] op_sel:[0,0,1] op_sel_hi:[1,0,1]
    v_cvt_pk_bf16_f32 v168, v226, v227
    v_cvt_pk_bf16_f32 v169, v228, v229
    v_cvt_pk_bf16_f32 v170, v230, v231
    v_cvt_pk_bf16_f32 v171, v232, v233
    ds_write_b128 v107, v[168:171] offset:0
    v_lshlrev_b32 v226, 16, v172
    v_and_b32 v227, 0xffff0000, v172
    buffer_load_dwordx4 v4, s[16:19], s92 offen offset:2048 lds
    v_lshlrev_b32 v228, 16, v173
    v_and_b32 v229, 0xffff0000, v173
    v_lshlrev_b32 v230, 16, v174
    v_and_b32 v231, 0xffff0000, v174
    v_lshlrev_b32 v232, 16, v175
    v_and_b32 v233, 0xffff0000, v175
    v_pk_fma_f32 v[226:227], v[226:227], v[222:223], v[222:223] op_sel:[0,0,1] op_sel_hi:[1,0,1]
    v_pk_fma_f32 v[228:229], v[228:229], v[222:223], v[222:223] op_sel:[0,0,1] op_sel_hi:[1,0,1]
    v_pk_fma_f32 v[230:231], v[230:231], v[222:223], v[222:223] op_sel:[0,0,1] op_sel_hi:[1,0,1]
    v_pk_fma_f32 v[232:233], v[232:233], v[222:223], v[222:223] op_sel:[0,0,1] op_sel_hi:[1,0,1]
    v_cvt_pk_bf16_f32 v172, v226, v227
    v_cvt_pk_bf16_f32 v173, v228, v229
    v_cvt_pk_bf16_f32 v174, v230, v231
    v_cvt_pk_bf16_f32 v175, v232, v233
    ds_write_b128 v107, v[172:175] offset:128
    v_lshlrev_b32 v226, 16, v176
    v_and_b32 v227, 0xffff0000, v176
    buffer_load_dwordx4 v5, s[16:19], s92 offen offset:3072 lds
    v_lshlrev_b32 v228, 16, v177
    v_and_b32 v229, 0xffff0000, v177
    v_lshlrev_b32 v230, 16, v178
    v_and_b32 v231, 0xffff0000, v178
    v_lshlrev_b32 v232, 16, v179
    v_and_b32 v233, 0xffff0000, v179
    v_pk_fma_f32 v[226:227], v[226:227], v[224:225], v[224:225] op_sel:[0,0,1] op_sel_hi:[1,0,1]
    v_pk_fma_f32 v[228:229], v[228:229], v[224:225], v[224:225] op_sel:[0,0,1] op_sel_hi:[1,0,1]
    v_pk_fma_f32 v[230:231], v[230:231], v[224:225], v[224:225] op_sel:[0,0,1] op_sel_hi:[1,0,1]
    v_pk_fma_f32 v[232:233], v[232:233], v[224:225], v[224:225] op_sel:[0,0,1] op_sel_hi:[1,0,1]
    v_cvt_pk_bf16_f32 v176, v226, v227
    v_cvt_pk_bf16_f32 v177, v228, v229
    v_cvt_pk_bf16_f32 v178, v230, v231
    v_cvt_pk_bf16_f32 v179, v232, v233
    ds_write_b128 v104, v[176:179] offset:8320
    v_lshlrev_b32 v226, 16, v180
    v_and_b32 v227, 0xffff0000, v180
    s_add_u32 s92, s66, 1792
    s_add_u32 m0, s72, 131072
    s_nop 0
    buffer_load_dwordx4 v2, s[16:19], s92 offen offset:0 lds
    v_lshlrev_b32 v228, 16, v181
    v_and_b32 v229, 0xffff0000, v181
    v_lshlrev_b32 v230, 16, v182
    v_and_b32 v231, 0xffff0000, v182
    v_lshlrev_b32 v232, 16, v183
    v_and_b32 v233, 0xffff0000, v183
    v_pk_fma_f32 v[226:227], v[226:227], v[224:225], v[224:225] op_sel:[0,0,1] op_sel_hi:[1,0,1]
    v_pk_fma_f32 v[228:229], v[228:229], v[224:225], v[224:225] op_sel:[0,0,1] op_sel_hi:[1,0,1]
    v_pk_fma_f32 v[230:231], v[230:231], v[224:225], v[224:225] op_sel:[0,0,1] op_sel_hi:[1,0,1]
    v_pk_fma_f32 v[232:233], v[232:233], v[224:225], v[224:225] op_sel:[0,0,1] op_sel_hi:[1,0,1]
    v_cvt_pk_bf16_f32 v180, v226, v227
    v_cvt_pk_bf16_f32 v181, v228, v229
    v_cvt_pk_bf16_f32 v182, v230, v231
    v_cvt_pk_bf16_f32 v183, v232, v233
    ds_write_b128 v104, v[180:183] offset:8192
    v_lshlrev_b32 v226, 16, v184
    buffer_load_dwordx4 v3, s[16:19], s92 offen offset:1024 lds
    v_and_b32 v227, 0xffff0000, v184
    v_lshlrev_b32 v228, 16, v185
    v_and_b32 v229, 0xffff0000, v185
    v_lshlrev_b32 v230, 16, v186
    v_and_b32 v231, 0xffff0000, v186
    v_lshlrev_b32 v232, 16, v187
    v_and_b32 v233, 0xffff0000, v187
    v_pk_fma_f32 v[226:227], v[226:227], v[224:225], v[224:225] op_sel:[0,0,1] op_sel_hi:[1,0,1]
    v_pk_fma_f32 v[228:229], v[228:229], v[224:225], v[224:225] op_sel:[0,0,1] op_sel_hi:[1,0,1]
    v_pk_fma_f32 v[230:231], v[230:231], v[224:225], v[224:225] op_sel:[0,0,1] op_sel_hi:[1,0,1]
    v_pk_fma_f32 v[232:233], v[232:233], v[224:225], v[224:225] op_sel:[0,0,1] op_sel_hi:[1,0,1]
    v_cvt_pk_bf16_f32 v184, v226, v227
    v_cvt_pk_bf16_f32 v185, v228, v229
    v_cvt_pk_bf16_f32 v186, v230, v231
    v_cvt_pk_bf16_f32 v187, v232, v233
    ds_write_b128 v105, v[184:187] offset:8320
    v_lshlrev_b32 v226, 16, v188
    buffer_load_dwordx4 v4, s[16:19], s92 offen offset:2048 lds
    v_and_b32 v227, 0xffff0000, v188
    v_lshlrev_b32 v228, 16, v189
    v_and_b32 v229, 0xffff0000, v189
    v_lshlrev_b32 v230, 16, v190
    v_and_b32 v231, 0xffff0000, v190
    v_lshlrev_b32 v232, 16, v191
    v_and_b32 v233, 0xffff0000, v191
    v_pk_fma_f32 v[226:227], v[226:227], v[224:225], v[224:225] op_sel:[0,0,1] op_sel_hi:[1,0,1]
    v_pk_fma_f32 v[228:229], v[228:229], v[224:225], v[224:225] op_sel:[0,0,1] op_sel_hi:[1,0,1]
    v_pk_fma_f32 v[230:231], v[230:231], v[224:225], v[224:225] op_sel:[0,0,1] op_sel_hi:[1,0,1]
    v_pk_fma_f32 v[232:233], v[232:233], v[224:225], v[224:225] op_sel:[0,0,1] op_sel_hi:[1,0,1]
    v_cvt_pk_bf16_f32 v188, v226, v227
    v_cvt_pk_bf16_f32 v189, v228, v229
    v_cvt_pk_bf16_f32 v190, v230, v231
    v_cvt_pk_bf16_f32 v191, v232, v233
    ds_write_b128 v105, v[188:191] offset:8192
    v_lshlrev_b32 v226, 16, v192
    buffer_load_dwordx4 v5, s[16:19], s92 offen offset:3072 lds
    v_and_b32 v227, 0xffff0000, v192
    v_lshlrev_b32 v228, 16, v193
    v_and_b32 v229, 0xffff0000, v193
    v_lshlrev_b32 v230, 16, v194
    v_and_b32 v231, 0xffff0000, v194
    v_lshlrev_b32 v232, 16, v195
    v_and_b32 v233, 0xffff0000, v195
    v_pk_fma_f32 v[226:227], v[226:227], v[224:225], v[224:225] op_sel:[0,0,1] op_sel_hi:[1,0,1]
    v_pk_fma_f32 v[228:229], v[228:229], v[224:225], v[224:225] op_sel:[0,0,1] op_sel_hi:[1,0,1]
    v_pk_fma_f32 v[230:231], v[230:231], v[224:225], v[224:225] op_sel:[0,0,1] op_sel_hi:[1,0,1]
    v_pk_fma_f32 v[232:233], v[232:233], v[224:225], v[224:225] op_sel:[0,0,1] op_sel_hi:[1,0,1]
    v_cvt_pk_bf16_f32 v192, v226, v227
    v_cvt_pk_bf16_f32 v193, v228, v229
    v_cvt_pk_bf16_f32 v194, v230, v231
    v_cvt_pk_bf16_f32 v195, v232, v233
    ds_write_b128 v106, v[192:195] offset:8320
    v_lshlrev_b32 v226, 16, v196
    s_add_u32 s92, s66, 1920
    s_add_u32 m0, s72, 147456
    s_nop 0
    buffer_load_dwordx4 v2, s[16:19], s92 offen offset:0 lds
    v_and_b32 v227, 0xffff0000, v196
    v_lshlrev_b32 v228, 16, v197
    v_and_b32 v229, 0xffff0000, v197
    v_lshlrev_b32 v230, 16, v198
    v_and_b32 v231, 0xffff0000, v198
    v_lshlrev_b32 v232, 16, v199
    v_and_b32 v233, 0xffff0000, v199
    v_pk_fma_f32 v[226:227], v[226:227], v[224:225], v[224:225] op_sel:[0,0,1] op_sel_hi:[1,0,1]
    v_pk_fma_f32 v[228:229], v[228:229], v[224:225], v[224:225] op_sel:[0,0,1] op_sel_hi:[1,0,1]
    v_pk_fma_f32 v[230:231], v[230:231], v[224:225], v[224:225] op_sel:[0,0,1] op_sel_hi:[1,0,1]
    v_pk_fma_f32 v[232:233], v[232:233], v[224:225], v[224:225] op_sel:[0,0,1] op_sel_hi:[1,0,1]
    v_cvt_pk_bf16_f32 v196, v226, v227
    v_cvt_pk_bf16_f32 v197, v228, v229
    v_cvt_pk_bf16_f32 v198, v230, v231
    v_cvt_pk_bf16_f32 v199, v232, v233
    ds_write_b128 v106, v[196:199] offset:8192
    v_lshlrev_b32 v226, 16, v200
    buffer_load_dwordx4 v3, s[16:19], s92 offen offset:1024 lds
    v_and_b32 v227, 0xffff0000, v200
    v_lshlrev_b32 v228, 16, v201
    v_and_b32 v229, 0xffff0000, v201
    v_lshlrev_b32 v230, 16, v202
    v_and_b32 v231, 0xffff0000, v202
    v_lshlrev_b32 v232, 16, v203
    v_and_b32 v233, 0xffff0000, v203
    v_pk_fma_f32 v[226:227], v[226:227], v[224:225], v[224:225] op_sel:[0,0,1] op_sel_hi:[1,0,1]
    v_pk_fma_f32 v[228:229], v[228:229], v[224:225], v[224:225] op_sel:[0,0,1] op_sel_hi:[1,0,1]
    v_pk_fma_f32 v[230:231], v[230:231], v[224:225], v[224:225] op_sel:[0,0,1] op_sel_hi:[1,0,1]
    v_pk_fma_f32 v[232:233], v[232:233], v[224:225], v[224:225] op_sel:[0,0,1] op_sel_hi:[1,0,1]
    v_cvt_pk_bf16_f32 v200, v226, v227
    v_cvt_pk_bf16_f32 v201, v228, v229
    v_cvt_pk_bf16_f32 v202, v230, v231
    v_cvt_pk_bf16_f32 v203, v232, v233
    ds_write_b128 v107, v[200:203] offset:8320
    v_lshlrev_b32 v226, 16, v204
    buffer_load_dwordx4 v4, s[16:19], s92 offen offset:2048 lds
    v_and_b32 v227, 0xffff0000, v204
    v_lshlrev_b32 v228, 16, v205
    v_and_b32 v229, 0xffff0000, v205
    v_lshlrev_b32 v230, 16, v206
    v_and_b32 v231, 0xffff0000, v206
    v_lshlrev_b32 v232, 16, v207
    v_and_b32 v233, 0xffff0000, v207
    v_pk_fma_f32 v[226:227], v[226:227], v[224:225], v[224:225] op_sel:[0,0,1] op_sel_hi:[1,0,1]
    v_pk_fma_f32 v[228:229], v[228:229], v[224:225], v[224:225] op_sel:[0,0,1] op_sel_hi:[1,0,1]
    v_pk_fma_f32 v[230:231], v[230:231], v[224:225], v[224:225] op_sel:[0,0,1] op_sel_hi:[1,0,1]
    v_pk_fma_f32 v[232:233], v[232:233], v[224:225], v[224:225] op_sel:[0,0,1] op_sel_hi:[1,0,1]
    v_cvt_pk_bf16_f32 v204, v226, v227
    v_cvt_pk_bf16_f32 v205, v228, v229
    v_cvt_pk_bf16_f32 v206, v230, v231
    v_cvt_pk_bf16_f32 v207, v232, v233
    ds_write_b128 v107, v[204:207] offset:8192
    buffer_load_dwordx4 v5, s[16:19], s92 offen offset:3072 lds
    v_bfe_u32 v101, v1, 4, 1
    v_mul_u32_u24 v100, 45056, v101
    v_lshrrev_b32 v101, 5, v1
    v_lshl_add_u32 v100, v101, 8, v100
    v_and_b32 v101, 15, v1
    v_lshl_add_u32 v100, v101, 4, v100
    s_mul_i32 s96, s44, 180224
    s_lshl_b32 s97, s45, 12
    s_add_u32 s96, s96, s97
    s_lshl_b32 s97, s46, 10
    s_add_u32 s96, s96, s97
    s_add_u32 s96, s96, 5259264
    s_cmp_eq_u32 s45, 7
    s_cselect_b32 s96, 0x7f000000, s96
    s_add_u32 s97, s96, 90112
    v_mov_b32 v96, -1
    v_mov_b32 v97, -1
    v_mov_b32 v98, -1
    v_mov_b32 v99, -1
    buffer_store_dwordx4 v[96:99], v100, s[36:39], s96 offen offset:0 sc1
    buffer_store_dwordx4 v[96:99], v100, s[36:39], s96 offen offset:512 sc1
    buffer_store_dwordx4 v[96:99], v100, s[36:39], s97 offen offset:0 sc1
    buffer_store_dwordx4 v[96:99], v100, s[36:39], s97 offen offset:512 sc1
    v_min_u32 v102, 5, v1
    v_lshlrev_b32 v102, 21, v102
    v_add_u32 v102, 0x80000, v102
    s_mov_b64 exec, 0x3f
    buffer_load_dword v0, v102, s[36:39], 0 offen
    s_mov_b64 exec, 1
    v_mov_b32 v102, 0x100000
    buffer_load_dword v0, v102, s[32:35], 0 offen
    s_mov_b64 exec, 0xf
    v_lshlrev_b32 v102, 21, v1
    buffer_load_dword v0, v102, s[20:23], 0 offen
    s_mov_b64 exec, -1
    s_cmp_lg_u32 s45, 7
    s_cbranch_scc1 L_mp_2
    v_lshrrev_b32 v102, 4, v1
    v_lshlrev_b32 v102, 12, v102
    v_and_b32 v103, 15, v1
    v_lshl_add_u32 v102, v103, 7, v102
    s_lshl_b32 s52, s44, 18
    s_lshl_b32 s53, s46, 16
    s_add_u32 s52, s52, s53
    buffer_load_dword v0, v102, s[20:23], s52 offen
    s_add_u32 s52, s52, 16384
    buffer_load_dword v0, v102, s[20:23], s52 offen
    s_add_u32 s52, s52, 16384
    buffer_load_dword v0, v102, s[20:23], s52 offen
    s_add_u32 s52, s52, 16384
    buffer_load_dword v0, v102, s[20:23], s52 offen
    s_add_u32 s52, s52, 16384
    v_lshrrev_b32 v102, 3, v1
    v_lshlrev_b32 v102, 10, v102
    v_and_b32 v103, 7, v1
    v_lshl_add_u32 v102, v103, 7, v102
    s_lshl_b32 s52, s44, 2
    s_add_u32 s52, s52, s46
    s_lshl_b32 s52, s52, 13
L_mp_2:
    s_waitcnt vmcnt(35)
    v_readfirstlane_b32 s47, v247
    s_nop 2
    s_mul_i32 s47, s47, 1664525
    s_add_u32 s47, s47, 1013904223
    s_lshl_b32 s52, s45, 9
    s_lshl_b32 s53, s46, 7
    s_add_u32 s52, s52, s53
    s_add_u32 s52, s52, 4096
    s_cmp_eq_u32 s44, 0
    s_cselect_b32 s52, s52, 0x7f000000
    v_mov_b32 v246, s47
    v_mov_b32 v247, 0
    s_mov_b64 exec, 1
    buffer_store_dword v246, v247, s[36:39], s52 offen sc1
    s_mov_b64 exec, -1
    s_waitcnt lgkmcnt(0)
    s_waitcnt vmcnt(28)
    s_barrier
    ds_read_b128 a[0:3], v128
    ds_read_b128 a[128:131], v136
    v_add_u32 v15, 65536, v13
    ds_read_b64_tr_b16 v[20:21], v15 offset:0
    ds_read_b64_tr_b16 v[22:23], v15 offset:512
    ds_read_b128 a[4:7], v129
    ds_read_b128 a[132:135], v137
    ds_read_b64_tr_b16 v[28:29], v15 offset:2048
    ds_read_b64_tr_b16 v[30:31], v15 offset:2560
    ds_read_b128 a[8:11], v130
    ds_read_b128 a[136:139], v138
    ds_read_b128 a[12:15], v131
    ds_read_b128 a[140:143], v139
    s_waitcnt lgkmcnt(8)
    v_mfma_f32_32x32x16_bf16 v[64:79], a[0:3], v[20:23], 0
    ds_read_b64_tr_b16 v[36:37], v15 offset:4096
    ds_read_b64_tr_b16 v[38:39], v15 offset:4608
    v_mfma_f32_32x32x16_bf16 v[80:95], a[128:131], v[20:23], 0
    ds_read_b128 a[16:19], v132
    ds_read_b128 a[144:147], v140
    ds_read_b128 a[20:23], v133
    ds_read_b128 a[148:151], v141
    ds_read_b128 a[24:27], v134
    ds_read_b128 a[152:155], v142
    s_waitcnt lgkmcnt(12)
    v_mfma_f32_32x32x16_bf16 v[64:79], a[4:7], v[28:31], v[64:79]
    ds_read_b64_tr_b16 v[44:45], v15 offset:6144
    ds_read_b64_tr_b16 v[46:47], v15 offset:6656
    v_mfma_f32_32x32x16_bf16 v[80:95], a[132:135], v[28:31], v[80:95]
    ds_read_b128 a[28:31], v135
    ds_read_b128 a[156:159], v143
    v_xor_b32 v128, 256, v128
    v_xor_b32 v129, 256, v129
    v_xor_b32 v130, 256, v130
    v_xor_b32 v131, 256, v131
    v_xor_b32 v132, 256, v132
    v_xor_b32 v133, 256, v133
    v_xor_b32 v134, 256, v134
    v_xor_b32 v135, 256, v135
    v_xor_b32 v136, 256, v136
    v_xor_b32 v137, 256, v137
    v_xor_b32 v138, 256, v138
    v_xor_b32 v139, 256, v139
    v_xor_b32 v140, 256, v140
    v_xor_b32 v141, 256, v141
    v_xor_b32 v142, 256, v142
    v_xor_b32 v143, 256, v143
    ds_read_b128 a[32:35], v128
    ds_read_b128 a[160:163], v136
    s_waitcnt lgkmcnt(12)
    v_mfma_f32_32x32x16_bf16 v[64:79], a[8:11], v[36:39], v[64:79]
    ds_read_b64_tr_b16 v[20:21], v15 offset:8192
    ds_read_b64_tr_b16 v[22:23], v15 offset:8704
    v_mfma_f32_32x32x16_bf16 v[80:95], a[136:139], v[36:39], v[80:95]
    ds_read_b128 a[36:39], v129
    ds_read_b128 a[164:167], v137
    ds_read_b128 a[40:43], v130
    ds_read_b128 a[168:171], v138
    s_waitcnt lgkmcnt(10)
    v_mfma_f32_32x32x16_bf16 v[64:79], a[12:15], v[44:47], v[64:79]
    ds_read_b64_tr_b16 v[28:29], v15 offset:10240
    ds_read_b64_tr_b16 v[30:31], v15 offset:10752
    v_mfma_f32_32x32x16_bf16 v[80:95], a[140:143], v[44:47], v[80:95]
    ds_read_b128 a[44:47], v131
    ds_read_b128 a[172:175], v139
    ds_read_b128 a[48:51], v132
    ds_read_b128 a[176:179], v140
    s_waitcnt lgkmcnt(10)
    v_mfma_f32_32x32x16_bf16 v[64:79], a[16:19], v[20:23], v[64:79]
    ds_read_b64_tr_b16 v[36:37], v15 offset:12288
    ds_read_b64_tr_b16 v[38:39], v15 offset:12800
    v_mfma_f32_32x32x16_bf16 v[80:95], a[144:147], v[20:23], v[80:95]
    ds_read_b128 a[52:55], v133
    ds_read_b128 a[180:183], v141
    ds_read_b128 a[56:59], v134
    ds_read_b128 a[184:187], v142
    s_waitcnt lgkmcnt(10)
    v_mfma_f32_32x32x16_bf16 v[64:79], a[20:23], v[28:31], v[64:79]
    ds_read_b64_tr_b16 v[44:45], v15 offset:14336
    ds_read_b64_tr_b16 v[46:47], v15 offset:14848
    v_mfma_f32_32x32x16_bf16 v[80:95], a[148:151], v[28:31], v[80:95]
    ds_read_b128 a[60:63], v135
    ds_read_b128 a[188:191], v143
    v_xor_b32 v128, 768, v128
    v_xor_b32 v129, 768, v129
    v_xor_b32 v130, 768, v130
    v_xor_b32 v131, 768, v131
    v_xor_b32 v132, 768, v132
    v_xor_b32 v133, 768, v133
    v_xor_b32 v134, 768, v134
    v_xor_b32 v135, 768, v135
    v_xor_b32 v136, 768, v136
    v_xor_b32 v137, 768, v137
    v_xor_b32 v138, 768, v138
    v_xor_b32 v139, 768, v139
    v_xor_b32 v140, 768, v140
    v_xor_b32 v141, 768, v141
    v_xor_b32 v142, 768, v142
    v_xor_b32 v143, 768, v143
    ds_read_b128 a[64:67], v128
    ds_read_b128 a[192:195], v136
    s_waitcnt vmcnt(16)
    s_barrier
    s_waitcnt lgkmcnt(10)
    v_mfma_f32_32x32x16_bf16 v[64:79], a[24:27], v[36:39], v[64:79]
    v_add_u32 v16, 98304, v13
    ds_read_b64_tr_b16 v[20:21], v16 offset:0
    ds_read_b64_tr_b16 v[22:23], v16 offset:512
    v_mfma_f32_32x32x16_bf16 v[80:95], a[152:155], v[36:39], v[80:95]
    ds_read_b128 a[68:71], v129
    ds_read_b128 a[196:199], v137
    ds_read_b128 a[72:75], v130
    ds_read_b128 a[200:203], v138
    ds_read_b128 a[76:79], v131
    ds_read_b128 a[204:207], v139
    s_waitcnt lgkmcnt(12)
    v_mfma_f32_32x32x16_bf16 v[64:79], a[28:31], v[44:47], v[64:79]
    ds_read_b64_tr_b16 v[28:29], v16 offset:2048
    ds_read_b64_tr_b16 v[30:31], v16 offset:2560
    v_mfma_f32_32x32x16_bf16 v[80:95], a[156:159], v[44:47], v[80:95]
    ds_read_b128 a[80:83], v132
    ds_read_b128 a[208:211], v140
    ds_read_b128 a[84:87], v133
    ds_read_b128 a[212:215], v141
    s_waitcnt lgkmcnt(12)
    v_mfma_f32_32x32x16_bf16 v[64:79], a[32:35], v[20:23], v[64:79]
    ds_read_b64_tr_b16 v[36:37], v16 offset:4096
    ds_read_b64_tr_b16 v[38:39], v16 offset:4608
    v_mfma_f32_32x32x16_bf16 v[80:95], a[160:163], v[20:23], v[80:95]
    ds_read_b128 a[88:91], v134
    ds_read_b128 a[216:219], v142
    ds_read_b128 a[92:95], v135
    ds_read_b128 a[220:223], v143
    s_waitcnt lgkmcnt(10)
    v_mfma_f32_32x32x16_bf16 v[64:79], a[36:39], v[28:31], v[64:79]
    ds_read_b64_tr_b16 v[44:45], v16 offset:6144
    ds_read_b64_tr_b16 v[46:47], v16 offset:6656
    v_mfma_f32_32x32x16_bf16 v[80:95], a[164:167], v[28:31], v[80:95]
    v_xor_b32 v128, 256, v128
    v_xor_b32 v129, 256, v129
    v_xor_b32 v130, 256, v130
    v_xor_b32 v131, 256, v131
    v_xor_b32 v132, 256, v132
    v_xor_b32 v133, 256, v133
    v_xor_b32 v134, 256, v134
    v_xor_b32 v135, 256, v135
    v_xor_b32 v136, 256, v136
    v_xor_b32 v137, 256, v137
    v_xor_b32 v138, 256, v138
    v_xor_b32 v139, 256, v139
    v_xor_b32 v140, 256, v140
    v_xor_b32 v141, 256, v141
    v_xor_b32 v142, 256, v142
    v_xor_b32 v143, 256, v143
    ds_read_b128 a[96:99], v128
    ds_read_b128 a[224:227], v136
    ds_read_b128 a[100:103], v129
    ds_read_b128 a[228:231], v137
    s_waitcnt lgkmcnt(10)
    v_mfma_f32_32x32x16_bf16 v[64:79], a[40:43], v[36:39], v[64:79]
    ds_read_b64_tr_b16 v[20:21], v16 offset:8192
    ds_read_b64_tr_b16 v[22:23], v16 offset:8704
    v_mfma_f32_32x32x16_bf16 v[80:95], a[168:171], v[36:39], v[80:95]
    ds_read_b128 a[104:107], v130
    ds_read_b128 a[232:235], v138
    ds_read_b128 a[108:111], v131
    ds_read_b128 a[236:239], v139
    s_waitcnt lgkmcnt(10)
    v_mfma_f32_32x32x16_bf16 v[64:79], a[44:47], v[44:47], v[64:79]
    ds_read_b64_tr_b16 v[28:29], v16 offset:10240
    ds_read_b64_tr_b16 v[30:31], v16 offset:10752
    v_mfma_f32_32x32x16_bf16 v[80:95], a[172:175], v[44:47], v[80:95]
    ds_read_b128 a[112:115], v132
    ds_read_b128 a[240:243], v140
    ds_read_b128 a[116:119], v133
    ds_read_b128 a[244:247], v141
    s_waitcnt lgkmcnt(10)
    v_mfma_f32_32x32x16_bf16 v[64:79], a[48:51], v[20:23], v[64:79]
    ds_read_b64_tr_b16 v[36:37], v16 offset:12288
    ds_read_b64_tr_b16 v[38:39], v16 offset:12800
    v_mfma_f32_32x32x16_bf16 v[80:95], a[176:179], v[20:23], v[80:95]
    ds_read_b128 a[120:123], v134
    ds_read_b128 a[248:251], v142
    ds_read_b128 a[124:127], v135
    ds_read_b128 a[252:255], v143
    s_waitcnt lgkmcnt(10)
    v_mfma_f32_32x32x16_bf16 v[64:79], a[52:55], v[28:31], v[64:79]
    ds_read_b64_tr_b16 v[44:45], v16 offset:14336
    ds_read_b64_tr_b16 v[46:47], v16 offset:14848
    v_mfma_f32_32x32x16_bf16 v[80:95], a[180:183], v[28:31], v[80:95]
    s_waitcnt vmcnt(8)
    s_waitcnt lgkmcnt(2)
    s_barrier
    v_mfma_f32_32x32x16_bf16 v[64:79], a[56:59], v[36:39], v[64:79]
    v_add_u32 v15, 131072, v13
    ds_read_b64_tr_b16 v[20:21], v15 offset:0
    ds_read_b64_tr_b16 v[22:23], v15 offset:512
    v_mfma_f32_32x32x16_bf16 v[80:95], a[184:187], v[36:39], v[80:95]
    s_waitcnt lgkmcnt(2)
    v_mfma_f32_32x32x16_bf16 v[64:79], a[60:63], v[44:47], v[64:79]
    ds_read_b64_tr_b16 v[28:29], v15 offset:2048
    ds_read_b64_tr_b16 v[30:31], v15 offset:2560
    s_add_u32 s92, s67, 1792
    s_add_u32 m0, s72, 0
    s_nop 0
    buffer_load_dwordx4 v2, s[16:19], s92 offen offset:0 lds
    v_mfma_f32_32x32x16_bf16 v[80:95], a[188:191], v[44:47], v[80:95]
    buffer_load_dwordx4 v3, s[16:19], s92 offen offset:1024 lds
    buffer_load_dwordx4 v4, s[16:19], s92 offen offset:2048 lds
    s_waitcnt lgkmcnt(2)
    v_mfma_f32_32x32x16_bf16 v[64:79], a[64:67], v[20:23], v[64:79]
    ds_read_b64_tr_b16 v[36:37], v15 offset:4096
    ds_read_b64_tr_b16 v[38:39], v15 offset:4608
    buffer_load_dwordx4 v5, s[16:19], s92 offen offset:3072 lds
    v_mfma_f32_32x32x16_bf16 v[80:95], a[192:195], v[20:23], v[80:95]
    s_add_u32 s92, s67, 1920
    s_add_u32 m0, s72, 16384
    s_nop 0
    buffer_load_dwordx4 v2, s[16:19], s92 offen offset:0 lds
    s_waitcnt lgkmcnt(2)
    v_mfma_f32_32x32x16_bf16 v[64:79], a[68:71], v[28:31], v[64:79]
    ds_read_b64_tr_b16 v[44:45], v15 offset:6144
    ds_read_b64_tr_b16 v[46:47], v15 offset:6656
    buffer_load_dwordx4 v3, s[16:19], s92 offen offset:1024 lds
    v_mfma_f32_32x32x16_bf16 v[80:95], a[196:199], v[28:31], v[80:95]
    buffer_load_dwordx4 v4, s[16:19], s92 offen offset:2048 lds
    s_waitcnt lgkmcnt(2)
    v_mfma_f32_32x32x16_bf16 v[64:79], a[72:75], v[36:39], v[64:79]
    ds_read_b64_tr_b16 v[20:21], v15 offset:8192
    ds_read_b64_tr_b16 v[22:23], v15 offset:8704
    buffer_load_dwordx4 v5, s[16:19], s92 offen offset:3072 lds
    v_mfma_f32_32x32x16_bf16 v[80:95], a[200:203], v[36:39], v[80:95]
    s_add_u32 s92, s68, 1024
    s_add_u32 m0, s72, 65536
    s_nop 0
    buffer_load_dwordx4 v9, s[12:15], s92 offen offset:0 lds
    buffer_load_dwordx4 v10, s[12:15], s92 offen offset:1024 lds
    s_waitcnt lgkmcnt(2)
    v_mfma_f32_32x32x16_bf16 v[64:79], a[76:79], v[44:47], v[64:79]
    ds_read_b64_tr_b16 v[28:29], v15 offset:10240
    ds_read_b64_tr_b16 v[30:31], v15 offset:10752
    buffer_load_dwordx4 v11, s[12:15], s92 offen offset:2048 lds
    v_mfma_f32_32x32x16_bf16 v[80:95], a[204:207], v[44:47], v[80:95]
    buffer_load_dwordx4 v12, s[12:15], s92 offen offset:3072 lds
    s_waitcnt lgkmcnt(2)
    v_mfma_f32_32x32x16_bf16 v[64:79], a[80:83], v[20:23], v[64:79]
    ds_read_b64_tr_b16 v[36:37], v15 offset:12288
    ds_read_b64_tr_b16 v[38:39], v15 offset:12800
    s_add_u32 s92, s68, 2048
    s_add_u32 m0, s72, 81920
    s_nop 0
    buffer_load_dwordx4 v9, s[12:15], s92 offen offset:0 lds
    v_mfma_f32_32x32x16_bf16 v[80:95], a[208:211], v[20:23], v[80:95]
    buffer_load_dwordx4 v10, s[12:15], s92 offen offset:1024 lds
    s_waitcnt lgkmcnt(2)
    v_mfma_f32_32x32x16_bf16 v[64:79], a[84:87], v[28:31], v[64:79]
    ds_read_b64_tr_b16 v[44:45], v15 offset:14336
    ds_read_b64_tr_b16 v[46:47], v15 offset:14848
    buffer_load_dwordx4 v11, s[12:15], s92 offen offset:2048 lds
    v_mfma_f32_32x32x16_bf16 v[80:95], a[212:215], v[28:31], v[80:95]
    buffer_load_dwordx4 v12, s[12:15], s92 offen offset:3072 lds
    s_waitcnt vmcnt(8)
    s_barrier
    s_waitcnt lgkmcnt(2)
    v_mfma_f32_32x32x16_bf16 v[64:79], a[88:91], v[36:39], v[64:79]
    v_add_u32 v16, 0, v13
    ds_read_b64_tr_b16 v[20:21], v16 offset:0
    ds_read_b64_tr_b16 v[22:23], v16 offset:512
    v_mfma_f32_32x32x16_bf16 v[80:95], a[216:219], v[36:39], v[80:95]
    s_waitcnt lgkmcnt(2)
    v_mfma_f32_32x32x16_bf16 v[64:79], a[92:95], v[44:47], v[64:79]
    ds_read_b64_tr_b16 v[28:29], v16 offset:2048
    ds_read_b64_tr_b16 v[30:31], v16 offset:2560
    s_add_u32 s92, s69, 1024
    s_add_u32 m0, s72, 98304
    s_nop 0
    buffer_load_dwordx4 v9, s[12:15], s92 offen offset:0 lds
    v_mfma_f32_32x32x16_bf16 v[80:95], a[220:223], v[44:47], v[80:95]
    buffer_load_dwordx4 v10, s[12:15], s92 offen offset:1024 lds
    s_waitcnt lgkmcnt(2)
    v_mfma_f32_32x32x16_bf16 v[64:79], a[96:99], v[20:23], v[64:79]
    ds_read_b64_tr_b16 v[36:37], v16 offset:4096
    ds_read_b64_tr_b16 v[38:39], v16 offset:4608
    buffer_load_dwordx4 v11, s[12:15], s92 offen offset:2048 lds
    v_mfma_f32_32x32x16_bf16 v[80:95], a[224:227], v[20:23], v[80:95]
    buffer_load_dwordx4 v12, s[12:15], s92 offen offset:3072 lds
    s_waitcnt lgkmcnt(2)
    v_mfma_f32_32x32x16_bf16 v[64:79], a[100:103], v[28:31], v[64:79]
    ds_read_b64_tr_b16 v[44:45], v16 offset:6144
    ds_read_b64_tr_b16 v[46:47], v16 offset:6656
    v_mfma_f32_32x32x16_bf16 v[80:95], a[228:231], v[28:31], v[80:95]
    s_add_u32 s92, s69, 2048
    s_add_u32 m0, s72, 114688
    s_nop 0
    buffer_load_dwordx4 v9, s[12:15], s92 offen offset:0 lds
    s_waitcnt lgkmcnt(2)
    v_mfma_f32_32x32x16_bf16 v[64:79], a[104:107], v[36:39], v[64:79]
    ds_read_b64_tr_b16 v[20:21], v16 offset:8192
    ds_read_b64_tr_b16 v[22:23], v16 offset:8704
    buffer_load_dwordx4 v10, s[12:15], s92 offen offset:1024 lds
    v_mfma_f32_32x32x16_bf16 v[80:95], a[232:235], v[36:39], v[80:95]
    buffer_load_dwordx4 v11, s[12:15], s92 offen offset:2048 lds
    s_waitcnt lgkmcnt(2)
    v_mfma_f32_32x32x16_bf16 v[64:79], a[108:111], v[44:47], v[64:79]
    ds_read_b64_tr_b16 v[28:29], v16 offset:10240
    ds_read_b64_tr_b16 v[30:31], v16 offset:10752
    v_mfma_f32_32x32x16_bf16 v[80:95], a[236:239], v[44:47], v[80:95]
    buffer_load_dwordx4 v12, s[12:15], s92 offen offset:3072 lds
    s_waitcnt lgkmcnt(2)
    v_mfma_f32_32x32x16_bf16 v[64:79], a[112:115], v[20:23], v[64:79]
    ds_read_b64_tr_b16 v[36:37], v16 offset:12288
    ds_read_b64_tr_b16 v[38:39], v16 offset:12800
    v_mfma_f32_32x32x16_bf16 v[80:95], a[240:243], v[20:23], v[80:95]
    s_waitcnt lgkmcnt(2)
    v_mfma_f32_32x32x16_bf16 v[64:79], a[116:119], v[28:31], v[64:79]
    ds_read_b64_tr_b16 v[44:45], v16 offset:14336
    ds_read_b64_tr_b16 v[46:47], v16 offset:14848
    v_mfma_f32_32x32x16_bf16 v[80:95], a[244:247], v[28:31], v[80:95]
    s_waitcnt vmcnt(8)
    s_barrier
    s_waitcnt lgkmcnt(2)
    v_mfma_f32_32x32x16_bf16 v[64:79], a[120:123], v[36:39], v[64:79]
    v_add_u32 v15, 65536, v14
    ds_read_b64_tr_b16 v[20:21], v15 offset:0
    ds_read_b64_tr_b16 v[22:23], v15 offset:512
    ds_read_b64_tr_b16 v[24:25], v15 offset:16384
    ds_read_b64_tr_b16 v[26:27], v15 offset:16896
    v_mfma_f32_32x32x16_bf16 v[80:95], a[248:251], v[36:39], v[80:95]
    s_waitcnt lgkmcnt(4)
    v_mfma_f32_32x32x16_bf16 v[64:79], a[124:127], v[44:47], v[64:79]
    ds_read_b64_tr_b16 v[28:29], v15 offset:2048
    ds_read_b64_tr_b16 v[30:31], v15 offset:2560
    ds_read_b64_tr_b16 v[32:33], v15 offset:18432
    ds_read_b64_tr_b16 v[34:35], v15 offset:18944
    v_mfma_f32_32x32x16_bf16 v[80:95], a[252:255], v[44:47], v[80:95]
    s_add_u32 s92, s70, 1024
    s_add_u32 m0, s72, 131072
    s_nop 0
    buffer_load_dwordx4 v9, s[12:15], s92 offen offset:0 lds
    buffer_load_dwordx4 v10, s[12:15], s92 offen offset:1024 lds
    s_waitcnt lgkmcnt(4)
    v_mfma_f32_32x32x16_bf16 v[96:111], a[0:3], v[20:23], 0
    ds_read_b64_tr_b16 v[36:37], v15 offset:4096
    ds_read_b64_tr_b16 v[38:39], v15 offset:4608
    ds_read_b64_tr_b16 v[40:41], v15 offset:20480
    ds_read_b64_tr_b16 v[42:43], v15 offset:20992
    buffer_load_dwordx4 v11, s[12:15], s92 offen offset:2048 lds
    v_mfma_f32_32x32x16_bf16 v[112:127], a[0:3], v[24:27], 0
    buffer_load_dwordx4 v12, s[12:15], s92 offen offset:3072 lds
    v_and_b32 v216, 31, v1
    s_lshl_b32 s48, s46, 5
    v_add_u32 v216, s48, v216
    v_mul_u32_u24 v216, 144, v216
    v_lshrrev_b32 v217, 5, v1
    v_lshl_add_u32 v216, v217, 4, v216
    s_lshl_b32 s48, s62, 6
    s_add_u32 s49, s48, 32768
    s_sub_u32 s50, 32832, s48
    v_add_u32 v217, s49, v216
    v_add_u32 v218, s50, v216
    v_mov_b32 v240, s56
    v_mov_b32 v241, v17
    v_mov_b32 v242, 1.0
    v_mov_b32 v243, 1.0
    v_pk_mul_f32 v[208:209], v[64:65], v[64:65]
    v_pk_mul_f32 v[210:211], v[66:67], v[66:67]
    v_pk_mul_f32 v[212:213], v[68:69], v[68:69]
    v_pk_mul_f32 v[214:215], v[70:71], v[70:71]
    v_pk_fma_f32 v[208:209], v[208:209], v[240:241], v[240:241] op_sel:[0,0,1] op_sel_hi:[1,0,1]
    v_pk_fma_f32 v[210:211], v[210:211], v[240:241], v[240:241] op_sel:[0,0,1] op_sel_hi:[1,0,1]
    v_pk_fma_f32 v[212:213], v[212:213], v[240:241], v[240:241] op_sel:[0,0,1] op_sel_hi:[1,0,1]
    v_pk_fma_f32 v[214:215], v[214:215], v[240:241], v[240:241] op_sel:[0,0,1] op_sel_hi:[1,0,1]
    v_pk_mul_f32 v[208:209], v[64:65], v[208:209]
    v_pk_mul_f32 v[210:211], v[66:67], v[210:211]
    v_pk_mul_f32 v[212:213], v[68:69], v[212:213]
    v_pk_mul_f32 v[214:215], v[70:71], v[214:215]
    v_exp_f32 v208, v208
    v_exp_f32 v209, v209
    v_exp_f32 v210, v210
    v_exp_f32 v211, v211
    v_exp_f32 v212, v212
    v_exp_f32 v213, v213
    v_exp_f32 v214, v214
    v_exp_f32 v215, v215
    v_pk_add_f32 v[208:209], v[208:209], v[242:243]
    v_pk_add_f32 v[210:211], v[210:211], v[242:243]
    v_pk_add_f32 v[212:213], v[212:213], v[242:243]
    v_pk_add_f32 v[214:215], v[214:215], v[242:243]
    v_rcp_f32 v208, v208
    v_rcp_f32 v209, v209
    v_rcp_f32 v210, v210
    v_rcp_f32 v211, v211
    v_rcp_f32 v212, v212
    v_rcp_f32 v213, v213
    v_rcp_f32 v214, v214
    v_rcp_f32 v215, v215
    v_pk_mul_f32 v[64:65], v[64:65], v[208:209]
    v_pk_mul_f32 v[66:67], v[66:67], v[210:211]
    v_pk_mul_f32 v[68:69], v[68:69], v[212:213]
    v_pk_mul_f32 v[70:71], v[70:71], v[214:215]
    v_cvt_pk_bf16_f32 v160, v64, v65
    v_cvt_pk_bf16_f32 v161, v66, v67
    v_cvt_pk_bf16_f32 v162, v68, v69
    v_cvt_pk_bf16_f32 v163, v70, v71
    ds_write_b128 v217, v[160:163] offset:0
    v_pk_mul_f32 v[208:209], v[72:73], v[72:73]
    v_pk_mul_f32 v[210:211], v[74:75], v[74:75]
    v_pk_mul_f32 v[212:213], v[76:77], v[76:77]
    v_pk_mul_f32 v[214:215], v[78:79], v[78:79]
    v_pk_fma_f32 v[208:209], v[208:209], v[240:241], v[240:241] op_sel:[0,0,1] op_sel_hi:[1,0,1]
    v_pk_fma_f32 v[210:211], v[210:211], v[240:241], v[240:241] op_sel:[0,0,1] op_sel_hi:[1,0,1]
    v_pk_fma_f32 v[212:213], v[212:213], v[240:241], v[240:241] op_sel:[0,0,1] op_sel_hi:[1,0,1]
    v_pk_fma_f32 v[214:215], v[214:215], v[240:241], v[240:241] op_sel:[0,0,1] op_sel_hi:[1,0,1]
    v_pk_mul_f32 v[208:209], v[72:73], v[208:209]
    v_pk_mul_f32 v[210:211], v[74:75], v[210:211]
    v_pk_mul_f32 v[212:213], v[76:77], v[212:213]
    v_pk_mul_f32 v[214:215], v[78:79], v[214:215]
    v_exp_f32 v208, v208
    v_exp_f32 v209, v209
    v_exp_f32 v210, v210
    v_exp_f32 v211, v211
    v_exp_f32 v212, v212
    v_exp_f32 v213, v213
    v_exp_f32 v214, v214
    v_exp_f32 v215, v215
    v_pk_add_f32 v[208:209], v[208:209], v[242:243]
    v_pk_add_f32 v[210:211], v[210:211], v[242:243]
    v_pk_add_f32 v[212:213], v[212:213], v[242:243]
    v_pk_add_f32 v[214:215], v[214:215], v[242:243]
    v_rcp_f32 v208, v208
    v_rcp_f32 v209, v209
    v_rcp_f32 v210, v210
    v_rcp_f32 v211, v211
    v_rcp_f32 v212, v212
    v_rcp_f32 v213, v213
    v_rcp_f32 v214, v214
    v_rcp_f32 v215, v215
    v_pk_mul_f32 v[72:73], v[72:73], v[208:209]
    v_pk_mul_f32 v[74:75], v[74:75], v[210:211]
    v_pk_mul_f32 v[76:77], v[76:77], v[212:213]
    v_pk_mul_f32 v[78:79], v[78:79], v[214:215]
    v_cvt_pk_bf16_f32 v164, v72, v73
    v_cvt_pk_bf16_f32 v165, v74, v75
    v_cvt_pk_bf16_f32 v166, v76, v77
    v_cvt_pk_bf16_f32 v167, v78, v79
    ds_write_b128 v217, v[164:167] offset:32
    v_pk_mul_f32 v[208:209], v[80:81], v[80:81]
    v_pk_mul_f32 v[210:211], v[82:83], v[82:83]
    v_pk_mul_f32 v[212:213], v[84:85], v[84:85]
    v_pk_mul_f32 v[214:215], v[86:87], v[86:87]
    v_pk_fma_f32 v[208:209], v[208:209], v[240:241], v[240:241] op_sel:[0,0,1] op_sel_hi:[1,0,1]
    v_pk_fma_f32 v[210:211], v[210:211], v[240:241], v[240:241] op_sel:[0,0,1] op_sel_hi:[1,0,1]
    v_pk_fma_f32 v[212:213], v[212:213], v[240:241], v[240:241] op_sel:[0,0,1] op_sel_hi:[1,0,1]
    v_pk_fma_f32 v[214:215], v[214:215], v[240:241], v[240:241] op_sel:[0,0,1] op_sel_hi:[1,0,1]
    v_pk_mul_f32 v[208:209], v[80:81], v[208:209]
    v_pk_mul_f32 v[210:211], v[82:83], v[210:211]
    v_pk_mul_f32 v[212:213], v[84:85], v[212:213]
    v_pk_mul_f32 v[214:215], v[86:87], v[214:215]
    v_exp_f32 v208, v208
    v_exp_f32 v209, v209
    v_exp_f32 v210, v210
    v_exp_f32 v211, v211
    v_exp_f32 v212, v212
    v_exp_f32 v213, v213
    v_exp_f32 v214, v214
    v_exp_f32 v215, v215
    v_pk_add_f32 v[208:209], v[208:209], v[242:243]
    v_pk_add_f32 v[210:211], v[210:211], v[242:243]
    v_pk_add_f32 v[212:213], v[212:213], v[242:243]
    v_pk_add_f32 v[214:215], v[214:215], v[242:243]
    v_rcp_f32 v208, v208
    v_rcp_f32 v209, v209
    v_rcp_f32 v210, v210
    v_rcp_f32 v211, v211
    v_rcp_f32 v212, v212
    v_rcp_f32 v213, v213
    v_rcp_f32 v214, v214
    v_rcp_f32 v215, v215
    v_pk_mul_f32 v[80:81], v[80:81], v[208:209]
    v_pk_mul_f32 v[82:83], v[82:83], v[210:211]
    v_pk_mul_f32 v[84:85], v[84:85], v[212:213]
    v_pk_mul_f32 v[86:87], v[86:87], v[214:215]
    v_cvt_pk_bf16_f32 v168, v80, v81
    v_cvt_pk_bf16_f32 v169, v82, v83
    v_cvt_pk_bf16_f32 v170, v84, v85
    v_cvt_pk_bf16_f32 v171, v86, v87
    ds_write_b128 v218, v[168:171] offset:0
    v_pk_mul_f32 v[208:209], v[88:89], v[88:89]
    v_pk_mul_f32 v[210:211], v[90:91], v[90:91]
    v_pk_mul_f32 v[212:213], v[92:93], v[92:93]
    v_pk_mul_f32 v[214:215], v[94:95], v[94:95]
    v_pk_fma_f32 v[208:209], v[208:209], v[240:241], v[240:241] op_sel:[0,0,1] op_sel_hi:[1,0,1]
    v_pk_fma_f32 v[210:211], v[210:211], v[240:241], v[240:241] op_sel:[0,0,1] op_sel_hi:[1,0,1]
    v_pk_fma_f32 v[212:213], v[212:213], v[240:241], v[240:241] op_sel:[0,0,1] op_sel_hi:[1,0,1]
    v_pk_fma_f32 v[214:215], v[214:215], v[240:241], v[240:241] op_sel:[0,0,1] op_sel_hi:[1,0,1]
    v_pk_mul_f32 v[208:209], v[88:89], v[208:209]
    v_pk_mul_f32 v[210:211], v[90:91], v[210:211]
    v_pk_mul_f32 v[212:213], v[92:93], v[212:213]
    v_pk_mul_f32 v[214:215], v[94:95], v[214:215]
    v_exp_f32 v208, v208
    v_exp_f32 v209, v209
    v_exp_f32 v210, v210
    v_exp_f32 v211, v211
    v_exp_f32 v212, v212
    v_exp_f32 v213, v213
    v_exp_f32 v214, v214
    v_exp_f32 v215, v215
    v_pk_add_f32 v[208:209], v[208:209], v[242:243]
    v_pk_add_f32 v[210:211], v[210:211], v[242:243]
    v_pk_add_f32 v[212:213], v[212:213], v[242:243]
    v_pk_add_f32 v[214:215], v[214:215], v[242:243]
    v_rcp_f32 v208, v208
    v_rcp_f32 v209, v209
    v_rcp_f32 v210, v210
    v_rcp_f32 v211, v211
    v_rcp_f32 v212, v212
    v_rcp_f32 v213, v213
    v_rcp_f32 v214, v214
    v_rcp_f32 v215, v215
    v_pk_mul_f32 v[88:89], v[88:89], v[208:209]
    v_pk_mul_f32 v[90:91], v[90:91], v[210:211]
    v_pk_mul_f32 v[92:93], v[92:93], v[212:213]
    v_pk_mul_f32 v[94:95], v[94:95], v[214:215]
    v_cvt_pk_bf16_f32 v172, v88, v89
    v_cvt_pk_bf16_f32 v173, v90, v91
    v_cvt_pk_bf16_f32 v174, v92, v93
    v_cvt_pk_bf16_f32 v175, v94, v95
    ds_write_b128 v218, v[172:175] offset:32
    s_waitcnt lgkmcnt(8)
    v_mfma_f32_32x32x16_bf16 v[96:111], a[4:7], v[28:31], v[96:111]
    ds_read_b64_tr_b16 v[44:45], v15 offset:6144
    ds_read_b64_tr_b16 v[46:47], v15 offset:6656
    ds_read_b64_tr_b16 v[48:49], v15 offset:22528
    ds_read_b64_tr_b16 v[50:51], v15 offset:23040
    v_mfma_f32_32x32x16_bf16 v[112:127], a[4:7], v[32:35], v[112:127]
    s_add_u32 s92, s70, 2048
    s_add_u32 m0, s72, 147456
    s_nop 0
    buffer_load_dwordx4 v9, s[12:15], s92 offen offset:0 lds
    s_waitcnt lgkmcnt(8)
    v_mfma_f32_32x32x16_bf16 v[96:111], a[8:11], v[36:39], v[96:111]
    ds_read_b64_tr_b16 v[20:21], v15 offset:8192
    ds_read_b64_tr_b16 v[22:23], v15 offset:8704
    ds_read_b64_tr_b16 v[24:25], v15 offset:24576
    ds_read_b64_tr_b16 v[26:27], v15 offset:25088
    buffer_load_dwordx4 v10, s[12:15], s92 offen offset:1024 lds
    buffer_load_dwordx4 v11, s[12:15], s92 offen offset:2048 lds
    v_mfma_f32_32x32x16_bf16 v[112:127], a[8:11], v[40:43], v[112:127]
    v_lshrrev_b32 v250, 4, v1
    v_lshlrev_b32 v250, 12, v250
    v_and_b32 v251, 15, v1
    v_lshl_add_u32 v250, v251, 7, v250
    s_lshl_b32 s96, s2, 15
    s_waitcnt lgkmcnt(4)
    v_mfma_f32_32x32x16_bf16 v[96:111], a[12:15], v[44:47], v[96:111]
    ds_read_b64_tr_b16 v[28:29], v15 offset:10240
    ds_read_b64_tr_b16 v[30:31], v15 offset:10752
    ds_read_b64_tr_b16 v[32:33], v15 offset:26624
    ds_read_b64_tr_b16 v[34:35], v15 offset:27136
    buffer_load_dwordx4 v12, s[12:15], s92 offen offset:3072 lds
    v_mfma_f32_32x32x16_bf16 v[112:127], a[12:15], v[48:51], v[112:127]
    s_add_u32 s96, s96, 2048
    s_cmp_eq_u32 s46, 0
    s_cselect_b32 s96, s96, 0x7f000000
    buffer_load_dword v0, v250, s[20:23], s96 offen
    s_waitcnt lgkmcnt(4)
    v_mfma_f32_32x32x16_bf16 v[96:111], a[16:19], v[20:23], v[96:111]
    ds_read_b64_tr_b16 v[36:37], v15 offset:12288
    ds_read_b64_tr_b16 v[38:39], v15 offset:12800
    ds_read_b64_tr_b16 v[40:41], v15 offset:28672
    ds_read_b64_tr_b16 v[42:43], v15 offset:29184
    v_mfma_f32_32x32x16_bf16 v[112:127], a[16:19], v[24:27], v[112:127]
    s_waitcnt lgkmcnt(4)
    v_mfma_f32_32x32x16_bf16 v[96:111], a[20:23], v[28:31], v[96:111]
    ds_read_b64_tr_b16 v[44:45], v15 offset:14336
    ds_read_b64_tr_b16 v[46:47], v15 offset:14848
    ds_read_b64_tr_b16 v[48:49], v15 offset:30720
    ds_read_b64_tr_b16 v[50:51], v15 offset:31232
    v_mfma_f32_32x32x16_bf16 v[112:127], a[20:23], v[32:35], v[112:127]
    s_waitcnt vmcnt(9)
    s_barrier
    s_waitcnt lgkmcnt(4)
    v_mfma_f32_32x32x16_bf16 v[96:111], a[24:27], v[36:39], v[96:111]
    v_add_u32 v16, 98304, v14
    ds_read_b64_tr_b16 v[20:21], v16 offset:0
    ds_read_b64_tr_b16 v[22:23], v16 offset:512
    ds_read_b64_tr_b16 v[24:25], v16 offset:16384
    ds_read_b64_tr_b16 v[26:27], v16 offset:16896
    v_mfma_f32_32x32x16_bf16 v[112:127], a[24:27], v[40:43], v[112:127]
    v_lshrrev_b32 v208, 2, v1
    v_mul_u32_u24 v208, 144, v208
    v_and_b32 v209, 3, v1
    v_lshl_add_u32 v208, v209, 3, v208
    s_lshl_b32 s48, s46, 5
    s_add_u32 s48, s48, 32768
    v_add_u32 v208, s48, v208
    ds_read_b64_tr_b16 v[160:161], v208 offset:0
    ds_read_b64_tr_b16 v[162:163], v208 offset:2304
    ds_read_b64_tr_b16 v[164:165], v208 offset:4608
    ds_read_b64_tr_b16 v[166:167], v208 offset:6912
    ds_read_b64_tr_b16 v[168:169], v208 offset:9216
    ds_read_b64_tr_b16 v[170:171], v208 offset:11520
    ds_read_b64_tr_b16 v[172:173], v208 offset:13824
    ds_read_b64_tr_b16 v[174:175], v208 offset:16128
    v_mov_b32 v214, 0x3f803f80
    v_mov_b32 v210, 0
    v_mov_b32 v211, 0
    v_mov_b32 v215, 0
    v_mov_b32 v216, 0
    s_lshl_b32 s48, s44, 3
    s_add_u32 s48, s48, s45
    s_lshl_b32 s48, s48, 10
    s_lshl_b32 s49, s46, 8
    s_add_u32 s48, s48, s49
    s_add_u32 s48, s48, 262144
    v_lshlrev_b32 v219, 4, v1
    s_waitcnt lgkmcnt(0)
    v_dot2_f32_bf16 v210, v160, v214, v210
    v_dot2_f32_bf16 v211, v160, v160, v211
    v_dot2_f32_bf16 v215, v161, v214, v215
    v_dot2_f32_bf16 v216, v161, v161, v216
    v_dot2_f32_bf16 v210, v162, v214, v210
    v_dot2_f32_bf16 v211, v162, v162, v211
    v_dot2_f32_bf16 v215, v163, v214, v215
    v_dot2_f32_bf16 v216, v163, v163, v216
    v_dot2_f32_bf16 v210, v164, v214, v210
    v_dot2_f32_bf16 v211, v164, v164, v211
    v_dot2_f32_bf16 v215, v165, v214, v215
    v_dot2_f32_bf16 v216, v165, v165, v216
    v_dot2_f32_bf16 v210, v166, v214, v210
    v_dot2_f32_bf16 v211, v166, v166, v211
    v_dot2_f32_bf16 v215, v167, v214, v215
    v_dot2_f32_bf16 v216, v167, v167, v216
    v_dot2_f32_bf16 v210, v168, v214, v210
    v_dot2_f32_bf16 v211, v168, v168, v211
    v_dot2_f32_bf16 v215, v169, v214, v215
    v_dot2_f32_bf16 v216, v169, v169, v216
    v_dot2_f32_bf16 v210, v170, v214, v210
    v_dot2_f32_bf16 v211, v170, v170, v211
    v_dot2_f32_bf16 v215, v171, v214, v215
    v_dot2_f32_bf16 v216, v171, v171, v216
    v_dot2_f32_bf16 v210, v172, v214, v210
    v_dot2_f32_bf16 v211, v172, v172, v211
    v_dot2_f32_bf16 v215, v173, v214, v215
    v_dot2_f32_bf16 v216, v173, v173, v216
    v_dot2_f32_bf16 v210, v174, v214, v210
    v_dot2_f32_bf16 v211, v174, v174, v211
    v_dot2_f32_bf16 v215, v175, v214, v215
    v_dot2_f32_bf16 v216, v175, v175, v216
    v_mov_b32 v212, s47
    v_mov_b32 v213, s47
    v_add_f32 v210, v210, v215
    v_add_f32 v211, v211, v216
    v_mov_b32 v217, v210
    v_mov_b32 v218, v211
    s_nop 0
    v_permlane16_swap_b32 v210, v217
    v_permlane16_swap_b32 v211, v218
    v_add_f32 v210, v210, v217
    v_add_f32 v211, v211, v218
    v_mov_b32 v217, v210
    v_mov_b32 v218, v211
    s_nop 0
    v_permlane32_swap_b32 v210, v217
    v_permlane32_swap_b32 v211, v218
    v_add_f32 v210, v210, v217
    v_add_f32 v211, v211, v218
    s_mov_b64 exec, 0xffff
    buffer_store_dwordx4 v[210:213], v219, s[36:39], s48 offen sc1
    s_mov_b64 exec, -1
    v_mfma_f32_32x32x16_bf16 v[96:111], a[28:31], v[44:47], v[96:111]
    ds_read_b64_tr_b16 v[28:29], v16 offset:2048
    ds_read_b64_tr_b16 v[30:31], v16 offset:2560
    ds_read_b64_tr_b16 v[32:33], v16 offset:18432
    ds_read_b64_tr_b16 v[34:35], v16 offset:18944
    v_mfma_f32_32x32x16_bf16 v[112:127], a[28:31], v[48:51], v[112:127]
    s_add_u32 s92, s71, 1024
    s_add_u32 m0, s72, 0
    s_nop 0
    buffer_load_dwordx4 v9, s[12:15], s92 offen offset:0 lds
    buffer_load_dwordx4 v10, s[12:15], s92 offen offset:1024 lds
    v_mfma_f32_32x32x16_bf16 v[96:111], a[32:35], v[20:23], v[96:111]
    ds_read_b64_tr_b16 v[36:37], v16 offset:4096
    ds_read_b64_tr_b16 v[38:39], v16 offset:4608
    ds_read_b64_tr_b16 v[40:41], v16 offset:20480
    ds_read_b64_tr_b16 v[42:43], v16 offset:20992
    buffer_load_dwordx4 v11, s[12:15], s92 offen offset:2048 lds
    v_mfma_f32_32x32x16_bf16 v[112:127], a[32:35], v[24:27], v[112:127]
    buffer_load_dwordx4 v12, s[12:15], s92 offen offset:3072 lds
    s_waitcnt lgkmcnt(4)
    v_mfma_f32_32x32x16_bf16 v[96:111], a[36:39], v[28:31], v[96:111]
    ds_read_b64_tr_b16 v[44:45], v16 offset:6144
    ds_read_b64_tr_b16 v[46:47], v16 offset:6656
    ds_read_b64_tr_b16 v[48:49], v16 offset:22528
    ds_read_b64_tr_b16 v[50:51], v16 offset:23040
    v_mfma_f32_32x32x16_bf16 v[112:127], a[36:39], v[32:35], v[112:127]
    s_add_u32 s92, s71, 2048
    s_add_u32 m0, s72, 16384
    s_nop 0
    buffer_load_dwordx4 v9, s[12:15], s92 offen offset:0 lds
    s_waitcnt lgkmcnt(4)
    v_mfma_f32_32x32x16_bf16 v[96:111], a[40:43], v[36:39], v[96:111]
    ds_read_b64_tr_b16 v[20:21], v16 offset:8192
    ds_read_b64_tr_b16 v[22:23], v16 offset:8704
    ds_read_b64_tr_b16 v[24:25], v16 offset:24576
    ds_read_b64_tr_b16 v[26:27], v16 offset:25088
    buffer_load_dwordx4 v10, s[12:15], s92 offen offset:1024 lds
    v_mfma_f32_32x32x16_bf16 v[112:127], a[40:43], v[40:43], v[112:127]
    buffer_load_dwordx4 v11, s[12:15], s92 offen offset:2048 lds
    s_waitcnt lgkmcnt(4)
    v_mfma_f32_32x32x16_bf16 v[96:111], a[44:47], v[44:47], v[96:111]
    ds_read_b64_tr_b16 v[28:29], v16 offset:10240
    ds_read_b64_tr_b16 v[30:31], v16 offset:10752
    ds_read_b64_tr_b16 v[32:33], v16 offset:26624
    ds_read_b64_tr_b16 v[34:35], v16 offset:27136
    v_mfma_f32_32x32x16_bf16 v[112:127], a[44:47], v[48:51], v[112:127]
    buffer_load_dwordx4 v12, s[12:15], s92 offen offset:3072 lds
    s_waitcnt lgkmcnt(4)
    v_mfma_f32_32x32x16_bf16 v[96:111], a[48:51], v[20:23], v[96:111]
    ds_read_b64_tr_b16 v[36:37], v16 offset:12288
    ds_read_b64_tr_b16 v[38:39], v16 offset:12800
    ds_read_b64_tr_b16 v[40:41], v16 offset:28672
    ds_read_b64_tr_b16 v[42:43], v16 offset:29184
    v_mfma_f32_32x32x16_bf16 v[112:127], a[48:51], v[24:27], v[112:127]
    s_waitcnt lgkmcnt(4)
    v_mfma_f32_32x32x16_bf16 v[96:111], a[52:55], v[28:31], v[96:111]
    ds_read_b64_tr_b16 v[44:45], v16 offset:14336
    ds_read_b64_tr_b16 v[46:47], v16 offset:14848
    ds_read_b64_tr_b16 v[48:49], v16 offset:30720
    ds_read_b64_tr_b16 v[50:51], v16 offset:31232
    v_mfma_f32_32x32x16_bf16 v[112:127], a[52:55], v[32:35], v[112:127]
    s_waitcnt vmcnt(10)
    s_barrier
    s_waitcnt lgkmcnt(4)
    v_mfma_f32_32x32x16_bf16 v[96:111], a[56:59], v[36:39], v[96:111]
    v_add_u32 v15, 131072, v14
    ds_read_b64_tr_b16 v[20:21], v15 offset:0
    ds_read_b64_tr_b16 v[22:23], v15 offset:512
    ds_read_b64_tr_b16 v[24:25], v15 offset:16384
    ds_read_b64_tr_b16 v[26:27], v15 offset:16896
    v_mfma_f32_32x32x16_bf16 v[112:127], a[56:59], v[40:43], v[112:127]
    s_waitcnt lgkmcnt(4)
    v_mfma_f32_32x32x16_bf16 v[96:111], a[60:63], v[44:47], v[96:111]
    ds_read_b64_tr_b16 v[28:29], v15 offset:2048
    ds_read_b64_tr_b16 v[30:31], v15 offset:2560
    ds_read_b64_tr_b16 v[32:33], v15 offset:18432
    ds_read_b64_tr_b16 v[34:35], v15 offset:18944
    v_mfma_f32_32x32x16_bf16 v[112:127], a[60:63], v[48:51], v[112:127]
    s_add_u32 s92, s64, 0
    s_add_u32 m0, s72, 65536
    s_nop 0
    buffer_load_dwordx4 v2, s[16:19], s92 offen offset:0 lds
    buffer_load_dwordx4 v3, s[16:19], s92 offen offset:1024 lds
    s_waitcnt lgkmcnt(4)
    v_mfma_f32_32x32x16_bf16 v[96:111], a[64:67], v[20:23], v[96:111]
    ds_read_b64_tr_b16 v[36:37], v15 offset:4096
    ds_read_b64_tr_b16 v[38:39], v15 offset:4608
    ds_read_b64_tr_b16 v[40:41], v15 offset:20480
    ds_read_b64_tr_b16 v[42:43], v15 offset:20992
    buffer_load_dwordx4 v4, s[16:19], s92 offen offset:2048 lds
    v_mfma_f32_32x32x16_bf16 v[112:127], a[64:67], v[24:27], v[112:127]
    buffer_load_dwordx4 v5, s[16:19], s92 offen offset:3072 lds
    s_waitcnt lgkmcnt(4)
    v_mfma_f32_32x32x16_bf16 v[96:111], a[68:71], v[28:31], v[96:111]
    ds_read_b64_tr_b16 v[44:45], v15 offset:6144
    ds_read_b64_tr_b16 v[46:47], v15 offset:6656
    ds_read_b64_tr_b16 v[48:49], v15 offset:22528
    ds_read_b64_tr_b16 v[50:51], v15 offset:23040
    v_mfma_f32_32x32x16_bf16 v[112:127], a[68:71], v[32:35], v[112:127]
    s_add_u32 s92, s64, 128
    s_add_u32 m0, s72, 81920
    s_nop 0
    buffer_load_dwordx4 v2, s[16:19], s92 offen offset:0 lds
    s_waitcnt lgkmcnt(4)
    v_mfma_f32_32x32x16_bf16 v[96:111], a[72:75], v[36:39], v[96:111]
    ds_read_b64_tr_b16 v[20:21], v15 offset:8192
    ds_read_b64_tr_b16 v[22:23], v15 offset:8704
    ds_read_b64_tr_b16 v[24:25], v15 offset:24576
    ds_read_b64_tr_b16 v[26:27], v15 offset:25088
    buffer_load_dwordx4 v3, s[16:19], s92 offen offset:1024 lds
    v_mfma_f32_32x32x16_bf16 v[112:127], a[72:75], v[40:43], v[112:127]
    buffer_load_dwordx4 v4, s[16:19], s92 offen offset:2048 lds
    s_waitcnt lgkmcnt(4)
    v_mfma_f32_32x32x16_bf16 v[96:111], a[76:79], v[44:47], v[96:111]
    ds_read_b64_tr_b16 v[28:29], v15 offset:10240
    ds_read_b64_tr_b16 v[30:31], v15 offset:10752
    ds_read_b64_tr_b16 v[32:33], v15 offset:26624
    ds_read_b64_tr_b16 v[34:35], v15 offset:27136
    v_mfma_f32_32x32x16_bf16 v[112:127], a[76:79], v[48:51], v[112:127]
    buffer_load_dwordx4 v5, s[16:19], s92 offen offset:3072 lds
    s_waitcnt lgkmcnt(4)
    v_mfma_f32_32x32x16_bf16 v[96:111], a[80:83], v[20:23], v[96:111]
    ds_read_b64_tr_b16 v[36:37], v15 offset:12288
    ds_read_b64_tr_b16 v[38:39], v15 offset:12800
    ds_read_b64_tr_b16 v[40:41], v15 offset:28672
    ds_read_b64_tr_b16 v[42:43], v15 offset:29184
    v_mfma_f32_32x32x16_bf16 v[112:127], a[80:83], v[24:27], v[112:127]
    s_waitcnt lgkmcnt(4)
    v_mfma_f32_32x32x16_bf16 v[96:111], a[84:87], v[28:31], v[96:111]
    ds_read_b64_tr_b16 v[44:45], v15 offset:14336
    ds_read_b64_tr_b16 v[46:47], v15 offset:14848
    ds_read_b64_tr_b16 v[48:49], v15 offset:30720
    ds_read_b64_tr_b16 v[50:51], v15 offset:31232
    v_and_b32 v244, 15, v1
    v_lshlrev_b32 v244, 4, v244
    v_mfma_f32_32x32x16_bf16 v[112:127], a[84:87], v[32:35], v[112:127]
    v_lshrrev_b32 v245, 4, v1
    v_lshl_add_u32 v244, v245, 11, v244
    s_lshl_b32 s96, s44, 13
    s_lshl_b32 s97, s46, 8
    s_add_u32 s96, s96, s97
    s_add_u32 s96, s96, 262144
    buffer_load_dwordx4 v[236:239], v244, s[36:39], s96 offen sc1
    buffer_load_dwordx4 v[240:243], v244, s[36:39], s96 offen offset:1024 sc1
    s_waitcnt vmcnt(10)
    s_barrier
    s_waitcnt lgkmcnt(4)
    v_mfma_f32_32x32x16_bf16 v[96:111], a[88:91], v[36:39], v[96:111]
    v_add_u32 v16, 0, v14
    ds_read_b64_tr_b16 v[20:21], v16 offset:0
    ds_read_b64_tr_b16 v[22:23], v16 offset:512
    ds_read_b64_tr_b16 v[24:25], v16 offset:16384
    ds_read_b64_tr_b16 v[26:27], v16 offset:16896
    v_mfma_f32_32x32x16_bf16 v[112:127], a[88:91], v[40:43], v[112:127]
    s_waitcnt lgkmcnt(4)
    v_mfma_f32_32x32x16_bf16 v[96:111], a[92:95], v[44:47], v[96:111]
    ds_read_b64_tr_b16 v[28:29], v16 offset:2048
    ds_read_b64_tr_b16 v[30:31], v16 offset:2560
    ds_read_b64_tr_b16 v[32:33], v16 offset:18432
    ds_read_b64_tr_b16 v[34:35], v16 offset:18944
    v_mfma_f32_32x32x16_bf16 v[112:127], a[92:95], v[48:51], v[112:127]
    s_add_u32 s92, s65, 0
    s_add_u32 m0, s72, 98304
    s_nop 0
    buffer_load_dwordx4 v2, s[16:19], s92 offen offset:0 lds
    buffer_load_dwordx4 v3, s[16:19], s92 offen offset:1024 lds
    s_waitcnt lgkmcnt(4)
    v_mfma_f32_32x32x16_bf16 v[96:111], a[96:99], v[20:23], v[96:111]
    ds_read_b64_tr_b16 v[36:37], v16 offset:4096
    ds_read_b64_tr_b16 v[38:39], v16 offset:4608
    ds_read_b64_tr_b16 v[40:41], v16 offset:20480
    ds_read_b64_tr_b16 v[42:43], v16 offset:20992
    buffer_load_dwordx4 v4, s[16:19], s92 offen offset:2048 lds
    v_mfma_f32_32x32x16_bf16 v[112:127], a[96:99], v[24:27], v[112:127]
    buffer_load_dwordx4 v5, s[16:19], s92 offen offset:3072 lds
    s_waitcnt lgkmcnt(4)
    v_mfma_f32_32x32x16_bf16 v[96:111], a[100:103], v[28:31], v[96:111]
    ds_read_b64_tr_b16 v[44:45], v16 offset:6144
    ds_read_b64_tr_b16 v[46:47], v16 offset:6656
    ds_read_b64_tr_b16 v[48:49], v16 offset:22528
    ds_read_b64_tr_b16 v[50:51], v16 offset:23040
    v_mfma_f32_32x32x16_bf16 v[112:127], a[100:103], v[32:35], v[112:127]
    s_add_u32 s92, s65, 128
    s_add_u32 m0, s72, 114688
    s_nop 0
    buffer_load_dwordx4 v2, s[16:19], s92 offen offset:0 lds
    s_waitcnt lgkmcnt(4)
    v_mfma_f32_32x32x16_bf16 v[96:111], a[104:107], v[36:39], v[96:111]
    ds_read_b64_tr_b16 v[20:21], v16 offset:8192
    ds_read_b64_tr_b16 v[22:23], v16 offset:8704
    ds_read_b64_tr_b16 v[24:25], v16 offset:24576
    ds_read_b64_tr_b16 v[26:27], v16 offset:25088
    buffer_load_dwordx4 v3, s[16:19], s92 offen offset:1024 lds
    v_mfma_f32_32x32x16_bf16 v[112:127], a[104:107], v[40:43], v[112:127]
    buffer_load_dwordx4 v4, s[16:19], s92 offen offset:2048 lds
    s_waitcnt lgkmcnt(4)
    v_mfma_f32_32x32x16_bf16 v[96:111], a[108:111], v[44:47], v[96:111]
    ds_read_b64_tr_b16 v[28:29], v16 offset:10240
    ds_read_b64_tr_b16 v[30:31], v16 offset:10752
    ds_read_b64_tr_b16 v[32:33], v16 offset:26624
    ds_read_b64_tr_b16 v[34:35], v16 offset:27136
    v_mfma_f32_32x32x16_bf16 v[112:127], a[108:111], v[48:51], v[112:127]
    buffer_load_dwordx4 v5, s[16:19], s92 offen offset:3072 lds
    s_waitcnt vmcnt(8)
    v_mov_b32 v245, s47
    s_mov_b32 exec_lo, 0
    s_mov_b32 exec_hi, 0xffff0000
    v_mov_b32 v240, 0
    v_mov_b32 v241, 0
    v_mov_b32 v242, s47
    v_mov_b32 v243, s47
    s_mov_b64 exec, -1
    v_xor_b32 v245, s47, v238
    v_xor_b32 v238, s47, v239
    v_or_b32 v245, v245, v238
    v_xor_b32 v238, s47, v242
    v_or_b32 v245, v245, v238
    v_xor_b32 v238, s47, v243
    v_or_b32 v245, v245, v238
    v_cmp_ne_u32 vcc, 0, v245
    s_mov_b32 s97, 0
    s_nop 3
    s_cbranch_vccz L_s1ok_4
L_s1_3:
    s_sleep 2
    buffer_load_dwordx4 v[236:239], v244, s[36:39], s96 offen sc1
    buffer_load_dwordx4 v[240:243], v244, s[36:39], s96 offen offset:1024 sc1
    s_waitcnt vmcnt(0)
    v_mov_b32 v245, s47
    s_mov_b32 exec_lo, 0
    s_mov_b32 exec_hi, 0xffff0000
    v_mov_b32 v240, 0
    v_mov_b32 v241, 0
    v_mov_b32 v242, s47
    v_mov_b32 v243, s47
    s_mov_b64 exec, -1
    v_xor_b32 v245, s47, v238
    v_xor_b32 v238, s47, v239
    v_or_b32 v245, v245, v238
    v_xor_b32 v238, s47, v242
    v_or_b32 v245, v245, v238
    v_xor_b32 v238, s47, v243
    v_or_b32 v245, v245, v238
    v_cmp_ne_u32 vcc, 0, v245
    s_add_u32 s97, s97, 1
    s_nop 3
    s_cbranch_vccz L_s1ok_4
    s_cmp_lt_u32 s97, 0x40000
    s_cbranch_scc1 L_s1_3
L_s1ok_4:
    v_add_f32 v236, v236, v240
    v_add_f32 v237, v237, v241
    v_mov_b32 v240, v236
    v_mov_b32 v241, v237
    s_nop 0
    v_permlane16_swap_b32 v236, v240
    v_permlane16_swap_b32 v237, v241
    v_add_f32 v236, v236, v240
    v_add_f32 v237, v237, v241
    v_mov_b32 v240, v236
    v_mov_b32 v241, v237
    s_nop 0
    v_permlane32_swap_b32 v236, v240
    v_permlane32_swap_b32 v237, v241
    v_add_f32 v236, v236, v240
    v_add_f32 v237, v237, v241
    v_mul_f32 v236, 0x3a924925, v236
    v_mul_f32 v237, 0x3a924925, v237
    v_fma_f32 v237, -v236, v236, v237
    v_max_f32 v237, 0, v237
    v_add_f32 v237, 0x3727c5ac, v237
    v_and_b32 v244, 15, v1
    v_lshlrev_b32 v244, 2, v244
    s_lshl_b32 s96, s46, 6
    s_add_u32 s96, s96, 51200
    v_rsq_f32 v237, v237
    v_add_u32 v244, s96, v244
    v_mul_f32 v236, -v236, v237
    s_mov_b64 exec, 0xffff
    ds_write_b32 v244, v237
    ds_write_b32 v244, v236 offset:256
    s_mov_b64 exec, -1
    s_waitcnt lgkmcnt(6)
    v_mfma_f32_32x32x16_bf16 v[96:111], a[112:115], v[20:23], v[96:111]
    ds_read_b64_tr_b16 v[36:37], v16 offset:12288
    ds_read_b64_tr_b16 v[38:39], v16 offset:12800
    ds_read_b64_tr_b16 v[40:41], v16 offset:28672
    ds_read_b64_tr_b16 v[42:43], v16 offset:29184
    v_mfma_f32_32x32x16_bf16 v[112:127], a[112:115], v[24:27], v[112:127]
    s_waitcnt lgkmcnt(6)
    v_mfma_f32_32x32x16_bf16 v[96:111], a[116:119], v[28:31], v[96:111]
    ds_read_b64_tr_b16 v[44:45], v16 offset:14336
    ds_read_b64_tr_b16 v[46:47], v16 offset:14848
    ds_read_b64_tr_b16 v[48:49], v16 offset:30720
    ds_read_b64_tr_b16 v[50:51], v16 offset:31232
    v_mfma_f32_32x32x16_bf16 v[112:127], a[116:119], v[32:35], v[112:127]
    s_waitcnt lgkmcnt(8)
    s_barrier
    s_waitcnt lgkmcnt(4)
    v_mfma_f32_32x32x16_bf16 v[96:111], a[120:123], v[36:39], v[96:111]
    v_add_u32 v15, 65536, v13
    ds_read_b64_tr_b16 v[20:21], v15 offset:0
    ds_read_b64_tr_b16 v[22:23], v15 offset:512
    v_mfma_f32_32x32x16_bf16 v[112:127], a[120:123], v[40:43], v[112:127]
    v_lshrrev_b32 v208, 5, v1
    v_lshlrev_b32 v208, 5, v208
    s_lshl_b32 s48, s62, 7
    s_add_u32 s49, s48, 51200
    s_sub_u32 s50, 51328, s48
    v_add_u32 v209, s49, v208
    v_add_u32 v210, s50, v208
    v_lshlrev_b32 v211, 4, v1
    s_lshl_b32 s54, s45, 19
    s_lshl_b32 s55, s46, 17
    s_add_u32 s54, s54, s55
    s_lshl_b32 s55, s44, 12
    s_add_u32 s54, s54, s55
    s_add_u32 s54, s54, 1048576
    s_lshl_b32 s55, s62, 11
    s_add_u32 s52, s54, s55
    s_sub_u32 s53, s54, s55
    s_add_u32 s53, s53, 2048
    ds_read_b128 v[216:219], v209 offset:0
    ds_read_b128 v[220:223], v209 offset:16
    ds_read_b128 v[224:227], v209 offset:256
    ds_read_b128 v[228:231], v209 offset:272
    s_waitcnt lgkmcnt(0)
    v_pk_fma_f32 v[64:65], v[64:65], v[216:217], v[224:225]
    v_pk_fma_f32 v[66:67], v[66:67], v[218:219], v[226:227]
    v_pk_fma_f32 v[68:69], v[68:69], v[220:221], v[228:229]
    v_pk_fma_f32 v[70:71], v[70:71], v[222:223], v[230:231]
    v_cvt_pk_bf16_f32 v232, v64, v65
    v_cvt_pk_bf16_f32 v233, v66, v67
    v_cvt_pk_bf16_f32 v234, v68, v69
    v_cvt_pk_bf16_f32 v235, v70, v71
    buffer_store_dwordx4 v[232:235], v211, s[36:39], s52 offen offset:0 sc1
    ds_read_b128 v[216:219], v209 offset:64
    ds_read_b128 v[220:223], v209 offset:80
    ds_read_b128 v[224:227], v209 offset:320
    ds_read_b128 v[228:231], v209 offset:336
    s_waitcnt lgkmcnt(0)
    v_pk_fma_f32 v[72:73], v[72:73], v[216:217], v[224:225]
    v_pk_fma_f32 v[74:75], v[74:75], v[218:219], v[226:227]
    v_pk_fma_f32 v[76:77], v[76:77], v[220:221], v[228:229]
    v_pk_fma_f32 v[78:79], v[78:79], v[222:223], v[230:231]
    v_cvt_pk_bf16_f32 v236, v72, v73
    v_cvt_pk_bf16_f32 v237, v74, v75
    v_cvt_pk_bf16_f32 v238, v76, v77
    v_cvt_pk_bf16_f32 v239, v78, v79
    buffer_store_dwordx4 v[236:239], v211, s[36:39], s52 offen offset:1024 sc1
    ds_read_b128 v[216:219], v210 offset:0
    ds_read_b128 v[220:223], v210 offset:16
    ds_read_b128 v[224:227], v210 offset:256
    ds_read_b128 v[228:231], v210 offset:272
    s_waitcnt lgkmcnt(0)
    v_pk_fma_f32 v[80:81], v[80:81], v[216:217], v[224:225]
    v_pk_fma_f32 v[82:83], v[82:83], v[218:219], v[226:227]
    v_pk_fma_f32 v[84:85], v[84:85], v[220:221], v[228:229]
    v_pk_fma_f32 v[86:87], v[86:87], v[222:223], v[230:231]
    v_cvt_pk_bf16_f32 v232, v80, v81
    v_cvt_pk_bf16_f32 v233, v82, v83
    v_cvt_pk_bf16_f32 v234, v84, v85
    v_cvt_pk_bf16_f32 v235, v86, v87
    buffer_store_dwordx4 v[232:235], v211, s[36:39], s53 offen offset:0 sc1
    ds_read_b128 v[216:219], v210 offset:64
    ds_read_b128 v[220:223], v210 offset:80
    ds_read_b128 v[224:227], v210 offset:320
    ds_read_b128 v[228:231], v210 offset:336
    s_waitcnt lgkmcnt(0)
    v_pk_fma_f32 v[88:89], v[88:89], v[216:217], v[224:225]
    v_pk_fma_f32 v[90:91], v[90:91], v[218:219], v[226:227]
    v_pk_fma_f32 v[92:93], v[92:93], v[220:221], v[228:229]
    v_pk_fma_f32 v[94:95], v[94:95], v[222:223], v[230:231]
    v_cvt_pk_bf16_f32 v236, v88, v89
    v_cvt_pk_bf16_f32 v237, v90, v91
    v_cvt_pk_bf16_f32 v238, v92, v93
    v_cvt_pk_bf16_f32 v239, v94, v95
    buffer_store_dwordx4 v[236:239], v211, s[36:39], s53 offen offset:1024 sc1
    v_mfma_f32_32x32x16_bf16 v[96:111], a[124:127], v[44:47], v[96:111]
    ds_read_b64_tr_b16 v[28:29], v15 offset:2048
    ds_read_b64_tr_b16 v[30:31], v15 offset:2560
    s_add_u32 s92, s66, 0
    s_add_u32 m0, s72, 131072
    s_nop 0
    buffer_load_dwordx4 v2, s[16:19], s92 offen offset:0 lds
    v_mfma_f32_32x32x16_bf16 v[112:127], a[124:127], v[48:51], v[112:127]
    buffer_load_dwordx4 v3, s[16:19], s92 offen offset:1024 lds
    v_mfma_f32_32x32x16_bf16 v[128:143], v[20:23], a[0:3], 0
    ds_read_b64_tr_b16 v[36:37], v15 offset:4096
    ds_read_b64_tr_b16 v[38:39], v15 offset:4608
    buffer_load_dwordx4 v4, s[16:19], s92 offen offset:2048 lds
    v_mfma_f32_32x32x16_bf16 v[144:159], v[20:23], a[128:131], 0
    buffer_load_dwordx4 v5, s[16:19], s92 offen offset:3072 lds
    s_waitcnt lgkmcnt(2)
    v_mfma_f32_32x32x16_bf16 v[128:143], v[28:31], a[4:7], v[128:143]
    ds_read_b64_tr_b16 v[44:45], v15 offset:6144
    ds_read_b64_tr_b16 v[46:47], v15 offset:6656
    v_mfma_f32_32x32x16_bf16 v[144:159], v[28:31], a[132:135], v[144:159]
    s_add_u32 s92, s66, 128
    s_add_u32 m0, s72, 147456
    s_nop 0
    buffer_load_dwordx4 v2, s[16:19], s92 offen offset:0 lds
    s_waitcnt lgkmcnt(2)
    v_mfma_f32_32x32x16_bf16 v[128:143], v[36:39], a[8:11], v[128:143]
    ds_read_b64_tr_b16 v[20:21], v15 offset:8192
    ds_read_b64_tr_b16 v[22:23], v15 offset:8704
    buffer_load_dwordx4 v3, s[16:19], s92 offen offset:1024 lds
    v_mfma_f32_32x32x16_bf16 v[144:159], v[36:39], a[136:139], v[144:159]
    buffer_load_dwordx4 v4, s[16:19], s92 offen offset:2048 lds
    s_waitcnt lgkmcnt(2)
    v_mfma_f32_32x32x16_bf16 v[128:143], v[44:47], a[12:15], v[128:143]
    ds_read_b64_tr_b16 v[28:29], v15 offset:10240
    ds_read_b64_tr_b16 v[30:31], v15 offset:10752
    v_mfma_f32_32x32x16_bf16 v[144:159], v[44:47], a[140:143], v[144:159]
    buffer_load_dwordx4 v5, s[16:19], s92 offen offset:3072 lds
    s_waitcnt lgkmcnt(2)
    v_mfma_f32_32x32x16_bf16 v[128:143], v[20:23], a[16:19], v[128:143]
    ds_read_b64_tr_b16 v[36:37], v15 offset:12288
    ds_read_b64_tr_b16 v[38:39], v15 offset:12800
    v_mfma_f32_32x32x16_bf16 v[144:159], v[20:23], a[144:147], v[144:159]
    s_waitcnt lgkmcnt(2)
    v_mfma_f32_32x32x16_bf16 v[128:143], v[28:31], a[20:23], v[128:143]
    ds_read_b64_tr_b16 v[44:45], v15 offset:14336
    ds_read_b64_tr_b16 v[46:47], v15 offset:14848
    v_mfma_f32_32x32x16_bf16 v[144:159], v[28:31], a[148:151], v[144:159]
    s_waitcnt vmcnt(12)
    s_barrier
    s_waitcnt lgkmcnt(2)
    v_mfma_f32_32x32x16_bf16 v[128:143], v[36:39], a[24:27], v[128:143]
    v_add_u32 v16, 98304, v13
    ds_read_b64_tr_b16 v[20:21], v16 offset:0
    ds_read_b64_tr_b16 v[22:23], v16 offset:512
    v_lshrrev_b32 v250, 4, v1
    v_lshlrev_b32 v250, 12, v250
    v_mfma_f32_32x32x16_bf16 v[144:159], v[36:39], a[152:155], v[144:159]
    v_and_b32 v251, 15, v1
    v_lshl_add_u32 v250, v251, 7, v250
    s_lshl_b32 s96, s2, 15
    s_waitcnt lgkmcnt(2)
    v_mfma_f32_32x32x16_bf16 v[128:143], v[44:47], a[28:31], v[128:143]
    ds_read_b64_tr_b16 v[28:29], v16 offset:2048
    ds_read_b64_tr_b16 v[30:31], v16 offset:2560
    s_add_u32 s92, s67, 0
    s_add_u32 m0, s72, 0
    s_nop 0
    buffer_load_dwordx4 v2, s[16:19], s92 offen offset:0 lds
    v_mfma_f32_32x32x16_bf16 v[144:159], v[44:47], a[156:159], v[144:159]
    buffer_load_dwordx4 v3, s[16:19], s92 offen offset:1024 lds
    s_add_u32 s96, s96, 18432
    s_cmp_eq_u32 s46, 1
    s_cselect_b32 s96, s96, 0x7f000000
    buffer_load_dword v0, v250, s[20:23], s96 offen
    s_waitcnt lgkmcnt(2)
    v_mfma_f32_32x32x16_bf16 v[128:143], v[20:23], a[32:35], v[128:143]
    ds_read_b64_tr_b16 v[36:37], v16 offset:4096
    ds_read_b64_tr_b16 v[38:39], v16 offset:4608
    buffer_load_dwordx4 v4, s[16:19], s92 offen offset:2048 lds
    v_mfma_f32_32x32x16_bf16 v[144:159], v[20:23], a[160:163], v[144:159]
    buffer_load_dwordx4 v5, s[16:19], s92 offen offset:3072 lds
    s_waitcnt lgkmcnt(2)
    v_mfma_f32_32x32x16_bf16 v[128:143], v[28:31], a[36:39], v[128:143]
    ds_read_b64_tr_b16 v[44:45], v16 offset:6144
    ds_read_b64_tr_b16 v[46:47], v16 offset:6656
    v_mfma_f32_32x32x16_bf16 v[144:159], v[28:31], a[164:167], v[144:159]
    s_add_u32 s92, s67, 128
    s_add_u32 m0, s72, 16384
    s_nop 0
    buffer_load_dwordx4 v2, s[16:19], s92 offen offset:0 lds
    s_waitcnt lgkmcnt(2)
    v_mfma_f32_32x32x16_bf16 v[128:143], v[36:39], a[40:43], v[128:143]
    ds_read_b64_tr_b16 v[20:21], v16 offset:8192
    ds_read_b64_tr_b16 v[22:23], v16 offset:8704
    buffer_load_dwordx4 v3, s[16:19], s92 offen offset:1024 lds
    v_mfma_f32_32x32x16_bf16 v[144:159], v[36:39], a[168:171], v[144:159]
    buffer_load_dwordx4 v4, s[16:19], s92 offen offset:2048 lds
    s_waitcnt lgkmcnt(2)
    v_mfma_f32_32x32x16_bf16 v[128:143], v[44:47], a[44:47], v[128:143]
    ds_read_b64_tr_b16 v[28:29], v16 offset:10240
    ds_read_b64_tr_b16 v[30:31], v16 offset:10752
    v_mfma_f32_32x32x16_bf16 v[144:159], v[44:47], a[172:175], v[144:159]
    buffer_load_dwordx4 v5, s[16:19], s92 offen offset:3072 lds
    s_waitcnt lgkmcnt(2)
    v_mfma_f32_32x32x16_bf16 v[128:143], v[20:23], a[48:51], v[128:143]
    ds_read_b64_tr_b16 v[36:37], v16 offset:12288
    ds_read_b64_tr_b16 v[38:39], v16 offset:12800
    v_mfma_f32_32x32x16_bf16 v[144:159], v[20:23], a[176:179], v[144:159]
    s_waitcnt lgkmcnt(2)
    v_mfma_f32_32x32x16_bf16 v[128:143], v[28:31], a[52:55], v[128:143]
    ds_read_b64_tr_b16 v[44:45], v16 offset:14336
    ds_read_b64_tr_b16 v[46:47], v16 offset:14848
    v_mfma_f32_32x32x16_bf16 v[144:159], v[28:31], a[180:183], v[144:159]
    s_waitcnt vmcnt(9)
    s_barrier
    s_lshl_b32 s96, s45, 5
    s_add_u32 s96, s96, s44
    s_lshl_b32 s96, s96, 7
    s_add_u32 s96, s96, 8192
    s_cmp_eq_u32 s46, 0
    s_cselect_b32 s96, s96, 0x7f000000
    v_mov_b32 v248, s47
    v_mov_b32 v249, 0
    s_mov_b64 exec, 1
    buffer_store_dword v248, v249, s[36:39], s96 offen sc1
    s_mov_b64 exec, -1
    s_waitcnt lgkmcnt(2)
    v_mfma_f32_32x32x16_bf16 v[128:143], v[36:39], a[56:59], v[128:143]
    v_add_u32 v15, 131072, v13
    ds_read_b64_tr_b16 v[20:21], v15 offset:0
    ds_read_b64_tr_b16 v[22:23], v15 offset:512
    v_mfma_f32_32x32x16_bf16 v[144:159], v[36:39], a[184:187], v[144:159]
    s_waitcnt lgkmcnt(2)
    v_mfma_f32_32x32x16_bf16 v[128:143], v[44:47], a[60:63], v[128:143]
    ds_read_b64_tr_b16 v[28:29], v15 offset:2048
    ds_read_b64_tr_b16 v[30:31], v15 offset:2560
    s_add_u32 s92, s68, 0
    s_add_u32 m0, s72, 65536
    s_nop 0
    buffer_load_dwordx4 v9, s[12:15], s92 offen offset:0 lds
    v_mfma_f32_32x32x16_bf16 v[144:159], v[44:47], a[188:191], v[144:159]
    buffer_load_dwordx4 v10, s[12:15], s92 offen offset:1024 lds
    s_waitcnt lgkmcnt(2)
    v_mfma_f32_32x32x16_bf16 v[128:143], v[20:23], a[64:67], v[128:143]
    ds_read_b64_tr_b16 v[36:37], v15 offset:4096
    ds_read_b64_tr_b16 v[38:39], v15 offset:4608
    buffer_load_dwordx4 v11, s[12:15], s92 offen offset:2048 lds
    v_mfma_f32_32x32x16_bf16 v[144:159], v[20:23], a[192:195], v[144:159]
    buffer_load_dwordx4 v12, s[12:15], s92 offen offset:3072 lds
    s_waitcnt lgkmcnt(2)
    v_mfma_f32_32x32x16_bf16 v[128:143], v[28:31], a[68:71], v[128:143]
    ds_read_b64_tr_b16 v[44:45], v15 offset:6144
    ds_read_b64_tr_b16 v[46:47], v15 offset:6656
    v_mfma_f32_32x32x16_bf16 v[144:159], v[28:31], a[196:199], v[144:159]
    s_add_u32 s92, s69, 0
    s_add_u32 m0, s72, 81920
    s_nop 0
    buffer_load_dwordx4 v9, s[12:15], s92 offen offset:0 lds
    s_waitcnt lgkmcnt(2)
    v_mfma_f32_32x32x16_bf16 v[128:143], v[36:39], a[72:75], v[128:143]
    ds_read_b64_tr_b16 v[20:21], v15 offset:8192
    ds_read_b64_tr_b16 v[22:23], v15 offset:8704
    buffer_load_dwordx4 v10, s[12:15], s92 offen offset:1024 lds
    v_mfma_f32_32x32x16_bf16 v[144:159], v[36:39], a[200:203], v[144:159]
    buffer_load_dwordx4 v11, s[12:15], s92 offen offset:2048 lds
    s_waitcnt lgkmcnt(2)
    v_mfma_f32_32x32x16_bf16 v[128:143], v[44:47], a[76:79], v[128:143]
    ds_read_b64_tr_b16 v[28:29], v15 offset:10240
    ds_read_b64_tr_b16 v[30:31], v15 offset:10752
    v_mfma_f32_32x32x16_bf16 v[144:159], v[44:47], a[204:207], v[144:159]
    buffer_load_dwordx4 v12, s[12:15], s92 offen offset:3072 lds
    s_waitcnt lgkmcnt(2)
    v_mfma_f32_32x32x16_bf16 v[128:143], v[20:23], a[80:83], v[128:143]
    ds_read_b64_tr_b16 v[36:37], v15 offset:12288
    ds_read_b64_tr_b16 v[38:39], v15 offset:12800
    v_mfma_f32_32x32x16_bf16 v[144:159], v[20:23], a[208:211], v[144:159]
    s_waitcnt lgkmcnt(2)
    v_mfma_f32_32x32x16_bf16 v[128:143], v[28:31], a[84:87], v[128:143]
    ds_read_b64_tr_b16 v[44:45], v15 offset:14336
    ds_read_b64_tr_b16 v[46:47], v15 offset:14848
    v_mfma_f32_32x32x16_bf16 v[144:159], v[28:31], a[212:215], v[144:159]
    s_waitcnt vmcnt(9)
    s_barrier
    s_waitcnt lgkmcnt(2)
    v_mfma_f32_32x32x16_bf16 v[128:143], v[36:39], a[88:91], v[128:143]
    v_add_u32 v16, 0, v13
    ds_read_b64_tr_b16 v[20:21], v16 offset:0
    ds_read_b64_tr_b16 v[22:23], v16 offset:512
    v_mfma_f32_32x32x16_bf16 v[144:159], v[36:39], a[216:219], v[144:159]
    s_waitcnt lgkmcnt(2)
    v_mfma_f32_32x32x16_bf16 v[128:143], v[44:47], a[92:95], v[128:143]
    ds_read_b64_tr_b16 v[28:29], v16 offset:2048
    ds_read_b64_tr_b16 v[30:31], v16 offset:2560
    s_add_u32 s92, s70, 0
    s_add_u32 m0, s72, 98304
    s_nop 0
    buffer_load_dwordx4 v9, s[12:15], s92 offen offset:0 lds
    v_mfma_f32_32x32x16_bf16 v[144:159], v[44:47], a[220:223], v[144:159]
    buffer_load_dwordx4 v10, s[12:15], s92 offen offset:1024 lds
    s_waitcnt lgkmcnt(2)
    v_mfma_f32_32x32x16_bf16 v[128:143], v[20:23], a[96:99], v[128:143]
    ds_read_b64_tr_b16 v[36:37], v16 offset:4096
    ds_read_b64_tr_b16 v[38:39], v16 offset:4608
    buffer_load_dwordx4 v11, s[12:15], s92 offen offset:2048 lds
    v_mfma_f32_32x32x16_bf16 v[144:159], v[20:23], a[224:227], v[144:159]
    buffer_load_dwordx4 v12, s[12:15], s92 offen offset:3072 lds
    s_waitcnt lgkmcnt(2)
    v_mfma_f32_32x32x16_bf16 v[128:143], v[28:31], a[100:103], v[128:143]
    ds_read_b64_tr_b16 v[44:45], v16 offset:6144
    ds_read_b64_tr_b16 v[46:47], v16 offset:6656
    v_mfma_f32_32x32x16_bf16 v[144:159], v[28:31], a[228:231], v[144:159]
    s_add_u32 s92, s71, 0
    s_add_u32 m0, s72, 114688
    s_nop 0
    buffer_load_dwordx4 v9, s[12:15], s92 offen offset:0 lds
    s_waitcnt lgkmcnt(2)
    v_mfma_f32_32x32x16_bf16 v[128:143], v[36:39], a[104:107], v[128:143]
    ds_read_b64_tr_b16 v[20:21], v16 offset:8192
    ds_read_b64_tr_b16 v[22:23], v16 offset:8704
    buffer_load_dwordx4 v10, s[12:15], s92 offen offset:1024 lds
    v_mfma_f32_32x32x16_bf16 v[144:159], v[36:39], a[232:235], v[144:159]
    buffer_load_dwordx4 v11, s[12:15], s92 offen offset:2048 lds
    s_waitcnt lgkmcnt(2)
    v_mfma_f32_32x32x16_bf16 v[128:143], v[44:47], a[108:111], v[128:143]
    ds_read_b64_tr_b16 v[28:29], v16 offset:10240
    ds_read_b64_tr_b16 v[30:31], v16 offset:10752
    v_mfma_f32_32x32x16_bf16 v[144:159], v[44:47], a[236:239], v[144:159]
    buffer_load_dwordx4 v12, s[12:15], s92 offen offset:3072 lds
    s_waitcnt lgkmcnt(2)
    v_mfma_f32_32x32x16_bf16 v[128:143], v[20:23], a[112:115], v[128:143]
    ds_read_b64_tr_b16 v[36:37], v16 offset:12288
    ds_read_b64_tr_b16 v[38:39], v16 offset:12800
    v_mfma_f32_32x32x16_bf16 v[144:159], v[20:23], a[240:243], v[144:159]
    s_waitcnt lgkmcnt(2)
    v_mfma_f32_32x32x16_bf16 v[128:143], v[28:31], a[116:119], v[128:143]
    ds_read_b64_tr_b16 v[44:45], v16 offset:14336
    ds_read_b64_tr_b16 v[46:47], v16 offset:14848
    v_mfma_f32_32x32x16_bf16 v[144:159], v[28:31], a[244:247], v[144:159]
    s_waitcnt vmcnt(8)
    s_barrier
    s_waitcnt lgkmcnt(2)
    v_mfma_f32_32x32x16_bf16 v[128:143], v[36:39], a[120:123], v[128:143]
    v_add_u32 v15, 65536, v14
    ds_read_b64_tr_b16 v[20:21], v15 offset:0
    ds_read_b64_tr_b16 v[22:23], v15 offset:512
    v_mfma_f32_32x32x16_bf16 v[144:159], v[36:39], a[248:251], v[144:159]
    s_waitcnt lgkmcnt(2)
    v_mfma_f32_32x32x16_bf16 v[128:143], v[44:47], a[124:127], v[128:143]
    ds_read_b64_tr_b16 v[28:29], v15 offset:2048
    ds_read_b64_tr_b16 v[30:31], v15 offset:2560
    v_lshrrev_b32 v252, 3, v1
    v_and_b32 v253, 7, v1
    v_lshrrev_b32 v254, 1, v252
    v_xor_b32 v253, v253, v254
    v_lshlrev_b32 v252, 12, v252
    v_lshl_add_u32 v2, v253, 4, v252
    v_xor_b32 v254, 4, v253
    v_mfma_f32_32x32x16_bf16 v[144:159], v[44:47], a[252:255], v[144:159]
    v_lshl_add_u32 v3, v254, 4, v252
    v_add_u32 v3, 31744, v3
    v_lshl_add_u32 v4, v253, 4, v252
    v_add_u32 v4, 63488, v4
    v_xor_b32 v254, 4, v253
    v_lshl_add_u32 v5, v254, 4, v252
    v_add_u32 v5, 95232, v5
    s_xor_b32 s92, s5, 0
    s_lshl_b32 s92, s92, 9
    s_add_u32 s92, s92, s74
    s_add_u32 s93, s92, 131072
    s_lshl_b32 s94, s72, 1
    s_add_u32 m0, s94, 131072
    s_nop 0
    buffer_load_dwordx4 v2, s[20:23], s92 offen offset:0 lds
    s_waitcnt lgkmcnt(2)
    v_mfma_f32_32x32x16_bf16 v[176:191], v[20:23], a[0:3], 0
    ds_read_b64_tr_b16 v[36:37], v15 offset:4096
    ds_read_b64_tr_b16 v[38:39], v15 offset:4608
    buffer_load_dwordx4 v3, s[20:23], s92 offen offset:1024 lds
    s_waitcnt lgkmcnt(2)
    v_mfma_f32_32x32x16_bf16 v[176:191], v[28:31], a[4:7], v[176:191]
    ds_read_b64_tr_b16 v[44:45], v15 offset:6144
    ds_read_b64_tr_b16 v[46:47], v15 offset:6656
    s_waitcnt lgkmcnt(2)
    v_mfma_f32_32x32x16_bf16 v[176:191], v[36:39], a[8:11], v[176:191]
    ds_read_b64_tr_b16 v[20:21], v15 offset:8192
    ds_read_b64_tr_b16 v[22:23], v15 offset:8704
    buffer_load_dwordx4 v4, s[20:23], s92 offen offset:2048 lds
    s_waitcnt lgkmcnt(2)
    v_mfma_f32_32x32x16_bf16 v[176:191], v[44:47], a[12:15], v[176:191]
    ds_read_b64_tr_b16 v[28:29], v15 offset:10240
    ds_read_b64_tr_b16 v[30:31], v15 offset:10752
    buffer_load_dwordx4 v5, s[20:23], s92 offen offset:3072 lds
    s_waitcnt lgkmcnt(2)
    v_mfma_f32_32x32x16_bf16 v[176:191], v[20:23], a[16:19], v[176:191]
    ds_read_b64_tr_b16 v[36:37], v15 offset:12288
    ds_read_b64_tr_b16 v[38:39], v15 offset:12800
    s_waitcnt lgkmcnt(2)
    v_mfma_f32_32x32x16_bf16 v[176:191], v[28:31], a[20:23], v[176:191]
    ds_read_b64_tr_b16 v[44:45], v15 offset:14336
    ds_read_b64_tr_b16 v[46:47], v15 offset:14848
    s_add_u32 m0, m0, 4096
    s_nop 0
    buffer_load_dwordx4 v2, s[20:23], s93 offen offset:0 lds
    s_waitcnt lgkmcnt(2)
    v_mfma_f32_32x32x16_bf16 v[176:191], v[36:39], a[24:27], v[176:191]
    ds_read_b64_tr_b16 v[20:21], v15 offset:16384
    ds_read_b64_tr_b16 v[22:23], v15 offset:16896
    buffer_load_dwordx4 v3, s[20:23], s93 offen offset:1024 lds
    s_waitcnt lgkmcnt(2)
    v_mfma_f32_32x32x16_bf16 v[176:191], v[44:47], a[28:31], v[176:191]
    ds_read_b64_tr_b16 v[28:29], v15 offset:18432
    ds_read_b64_tr_b16 v[30:31], v15 offset:18944
    s_waitcnt lgkmcnt(2)
    v_mfma_f32_32x32x16_bf16 v[176:191], v[20:23], a[32:35], v[176:191]
    ds_read_b64_tr_b16 v[36:37], v15 offset:20480
    ds_read_b64_tr_b16 v[38:39], v15 offset:20992
    buffer_load_dwordx4 v4, s[20:23], s93 offen offset:2048 lds
    v_lshlrev_b32 v18, 4, v1
    v_and_b32 v250, 0x13, v1
    v_bfe_u32 v251, v1, 2, 1
    v_lshl_or_b32 v250, v251, 3, v250
    s_waitcnt lgkmcnt(2)
    v_mfma_f32_32x32x16_bf16 v[176:191], v[28:31], a[36:39], v[176:191]
    ds_read_b64_tr_b16 v[44:45], v15 offset:22528
    ds_read_b64_tr_b16 v[46:47], v15 offset:23040
    buffer_load_dwordx4 v5, s[20:23], s93 offen offset:3072 lds
    v_bfe_u32 v251, v1, 3, 1
    v_lshl_or_b32 v250, v251, 2, v250
    v_lshlrev_b32 v250, 1, v250
    s_waitcnt lgkmcnt(2)
    v_mfma_f32_32x32x16_bf16 v[176:191], v[36:39], a[40:43], v[176:191]
    ds_read_b64_tr_b16 v[20:21], v15 offset:24576
    ds_read_b64_tr_b16 v[22:23], v15 offset:25088
    s_lshl_b32 s96, s44, 7
    s_lshl_b32 s97, s62, 6
    s_add_u32 s98, s96, s97
    s_waitcnt lgkmcnt(2)
    v_mfma_f32_32x32x16_bf16 v[176:191], v[44:47], a[44:47], v[176:191]
    ds_read_b64_tr_b16 v[28:29], v15 offset:26624
    ds_read_b64_tr_b16 v[30:31], v15 offset:27136
    s_xor_b32 s97, s97, 64
    s_add_u32 s97, s96, s97
    buffer_load_ushort v60, v250, s[40:43], s98 offen
    buffer_load_ushort v61, v250, s[40:43], s97 offen
    s_waitcnt lgkmcnt(2)
    v_mfma_f32_32x32x16_bf16 v[176:191], v[20:23], a[48:51], v[176:191]
    ds_read_b64_tr_b16 v[36:37], v15 offset:28672
    ds_read_b64_tr_b16 v[38:39], v15 offset:29184
    s_lshl_b32 s86, s45, 19
    s_lshl_b32 s96, s46, 17
    s_add_u32 s86, s86, s96
    s_waitcnt lgkmcnt(2)
    v_mfma_f32_32x32x16_bf16 v[176:191], v[28:31], a[52:55], v[176:191]
    ds_read_b64_tr_b16 v[44:45], v15 offset:30720
    ds_read_b64_tr_b16 v[46:47], v15 offset:31232
    s_add_u32 s86, s86, 1048576
    s_cmp_eq_u32 s45, 7
    s_cselect_b32 s73, 0x7f000000, s86
    s_waitcnt vmcnt(10)
    s_barrier
    s_waitcnt lgkmcnt(2)
    v_mfma_f32_32x32x16_bf16 v[176:191], v[36:39], a[56:59], v[176:191]
    v_add_u32 v16, 98304, v14
    ds_read_b64_tr_b16 v[20:21], v16 offset:0
    ds_read_b64_tr_b16 v[22:23], v16 offset:512
    s_waitcnt lgkmcnt(2)
    v_mfma_f32_32x32x16_bf16 v[176:191], v[44:47], a[60:63], v[176:191]
    ds_read_b64_tr_b16 v[28:29], v16 offset:2048
    ds_read_b64_tr_b16 v[30:31], v16 offset:2560
    s_xor_b32 s92, s5, 1
    s_lshl_b32 s92, s92, 9
    s_add_u32 s92, s92, s74
    s_add_u32 s93, s92, 131072
    s_lshl_b32 s94, s72, 1
    s_add_u32 m0, s94, 0
    s_nop 0
    buffer_load_dwordx4 v2, s[20:23], s92 offen offset:0 lds
    s_waitcnt lgkmcnt(2)
    v_mfma_f32_32x32x16_bf16 v[176:191], v[20:23], a[64:67], v[176:191]
    ds_read_b64_tr_b16 v[36:37], v16 offset:4096
    ds_read_b64_tr_b16 v[38:39], v16 offset:4608
    buffer_load_dwordx4 v3, s[20:23], s92 offen offset:1024 lds
    v_and_b32 v246, 3, v1
    v_lshlrev_b32 v246, 7, v246
    s_lshl_b32 s98, s45, 9
    s_add_u32 s98, s98, 4096
    buffer_load_dword v247, v246, s[36:39], s98 offen sc1
    s_waitcnt lgkmcnt(2)
    v_mfma_f32_32x32x16_bf16 v[176:191], v[28:31], a[68:71], v[176:191]
    ds_read_b64_tr_b16 v[44:45], v16 offset:6144
    ds_read_b64_tr_b16 v[46:47], v16 offset:6656
    s_waitcnt lgkmcnt(2)
    v_mfma_f32_32x32x16_bf16 v[176:191], v[36:39], a[72:75], v[176:191]
    ds_read_b64_tr_b16 v[20:21], v16 offset:8192
    ds_read_b64_tr_b16 v[22:23], v16 offset:8704
    buffer_load_dwordx4 v4, s[20:23], s92 offen offset:2048 lds
    s_waitcnt lgkmcnt(2)
    v_mfma_f32_32x32x16_bf16 v[176:191], v[44:47], a[76:79], v[176:191]
    ds_read_b64_tr_b16 v[28:29], v16 offset:10240
    ds_read_b64_tr_b16 v[30:31], v16 offset:10752
    buffer_load_dwordx4 v5, s[20:23], s92 offen offset:3072 lds
    s_waitcnt lgkmcnt(2)
    v_mfma_f32_32x32x16_bf16 v[176:191], v[20:23], a[80:83], v[176:191]
    ds_read_b64_tr_b16 v[36:37], v16 offset:12288
    ds_read_b64_tr_b16 v[38:39], v16 offset:12800
    s_waitcnt lgkmcnt(2)
    v_mfma_f32_32x32x16_bf16 v[176:191], v[28:31], a[84:87], v[176:191]
    ds_read_b64_tr_b16 v[44:45], v16 offset:14336
    ds_read_b64_tr_b16 v[46:47], v16 offset:14848
    s_add_u32 m0, m0, 4096
    s_nop 0
    buffer_load_dwordx4 v2, s[20:23], s93 offen offset:0 lds
    s_waitcnt lgkmcnt(2)
    v_mfma_f32_32x32x16_bf16 v[176:191], v[36:39], a[88:91], v[176:191]
    ds_read_b64_tr_b16 v[20:21], v16 offset:16384
    ds_read_b64_tr_b16 v[22:23], v16 offset:16896
    buffer_load_dwordx4 v3, s[20:23], s93 offen offset:1024 lds
    s_waitcnt lgkmcnt(2)
    v_mfma_f32_32x32x16_bf16 v[176:191], v[44:47], a[92:95], v[176:191]
    ds_read_b64_tr_b16 v[28:29], v16 offset:18432
    ds_read_b64_tr_b16 v[30:31], v16 offset:18944
    s_waitcnt lgkmcnt(2)
    v_mfma_f32_32x32x16_bf16 v[176:191], v[20:23], a[96:99], v[176:191]
    ds_read_b64_tr_b16 v[36:37], v16 offset:20480
    ds_read_b64_tr_b16 v[38:39], v16 offset:20992
    buffer_load_dwordx4 v4, s[20:23], s93 offen offset:2048 lds
    s_waitcnt lgkmcnt(2)
    v_mfma_f32_32x32x16_bf16 v[176:191], v[28:31], a[100:103], v[176:191]
    ds_read_b64_tr_b16 v[44:45], v16 offset:22528
    ds_read_b64_tr_b16 v[46:47], v16 offset:23040
    buffer_load_dwordx4 v5, s[20:23], s93 offen offset:3072 lds
    s_waitcnt lgkmcnt(2)
    v_mfma_f32_32x32x16_bf16 v[176:191], v[36:39], a[104:107], v[176:191]
    ds_read_b64_tr_b16 v[20:21], v16 offset:24576
    ds_read_b64_tr_b16 v[22:23], v16 offset:25088
    s_waitcnt lgkmcnt(2)
    v_mfma_f32_32x32x16_bf16 v[176:191], v[44:47], a[108:111], v[176:191]
    ds_read_b64_tr_b16 v[28:29], v16 offset:26624
    ds_read_b64_tr_b16 v[30:31], v16 offset:27136
    s_waitcnt lgkmcnt(2)
    v_mfma_f32_32x32x16_bf16 v[176:191], v[20:23], a[112:115], v[176:191]
    ds_read_b64_tr_b16 v[36:37], v16 offset:28672
    ds_read_b64_tr_b16 v[38:39], v16 offset:29184
    s_waitcnt lgkmcnt(2)
    v_mfma_f32_32x32x16_bf16 v[176:191], v[28:31], a[116:119], v[176:191]
    ds_read_b64_tr_b16 v[44:45], v16 offset:30720
    ds_read_b64_tr_b16 v[46:47], v16 offset:31232
    s_waitcnt vmcnt(11)
    s_barrier
    s_waitcnt lgkmcnt(2)
    v_mfma_f32_32x32x16_bf16 v[176:191], v[36:39], a[120:123], v[176:191]
    s_waitcnt lgkmcnt(0)
    v_mfma_f32_32x32x16_bf16 v[176:191], v[44:47], a[124:127], v[176:191]
    s_xor_b32 s92, s5, 2
    s_lshl_b32 s92, s92, 9
    s_add_u32 s92, s92, s74
    s_add_u32 s93, s92, 131072
    s_lshl_b32 s94, s72, 1
    s_add_u32 m0, s94, 65536
    s_nop 0
    buffer_load_dwordx4 v2, s[20:23], s92 offen offset:0 lds
    v_and_b32 v248, 31, v1
    v_lshlrev_b32 v248, 7, v248
    s_lshl_b32 s96, s45, 12
    s_add_u32 s96, s96, 8192
    buffer_load_dword v249, v248, s[36:39], s96 offen sc1
    v_and_b32 v208, 0x13, v1
    v_bfe_u32 v209, v1, 2, 1
    v_lshl_or_b32 v208, v209, 3, v208
    v_bfe_u32 v209, v1, 3, 1
    v_lshl_or_b32 v208, v209, 2, v208
    v_bfe_u32 v209, v208, 1, 3
    v_lshrrev_b32 v210, 5, v1
    v_xor_b32 v209, v209, v210
    v_lshlrev_b32 v208, 7, v208
    s_lshl_b32 s48, s62, 12
    s_xor_b32 s49, s48, 4096
    s_add_u32 s48, s48, 131072
    s_add_u32 s49, s49, 131072
    v_xor_b32 v210, 0, v209
    v_lshl_add_u32 v210, v210, 4, v208
    v_add_u32 v20, s48, v210
    v_add_u32 v24, s49, v210
    v_xor_b32 v210, 2, v209
    v_lshl_add_u32 v210, v210, 4, v208
    v_add_u32 v21, s48, v210
    v_add_u32 v25, s49, v210
    v_xor_b32 v210, 4, v209
    v_lshl_add_u32 v210, v210, 4, v208
    v_add_u32 v22, s48, v210
    v_add_u32 v26, s49, v210
    v_xor_b32 v210, 6, v209
    v_lshl_add_u32 v210, v210, 4, v208
    v_add_u32 v23, s48, v210
    v_add_u32 v27, s49, v210
    ds_read_b128 v[28:31], v20 offset:0
    ds_read_b128 v[32:35], v24 offset:0
    ds_read_b128 v[36:39], v21 offset:0
    ds_read_b128 v[40:43], v25 offset:0
    s_waitcnt vmcnt(0)
    v_cmp_ne_u32 vcc, s47, v249
    s_mov_b32 s97, 0
    s_nop 3
    s_cbranch_vccz L_s2ok_8
L_s2_7:
    s_sleep 2
    buffer_load_dword v249, v248, s[36:39], s96 offen sc1
    s_waitcnt vmcnt(0)
    v_cmp_ne_u32 vcc, s47, v249
    s_add_u32 s97, s97, 1
    s_nop 3
    s_cbranch_vccz L_s2ok_8
    s_cmp_lt_u32 s97, 0x40000
    s_cbranch_scc1 L_s2_7
L_s2ok_8:
    s_xor_b32 s86, s5, 0
    s_lshl_b32 s86, s86, 14
    s_add_u32 s86, s86, s73
    buffer_load_dwordx4 a[128:131], v18, s[36:39], s86 offen offset:0 sc1
    buffer_load_dwordx4 a[132:135], v18, s[36:39], s86 offen offset:1024 sc1
    v_cvt_pk_bf16_f32 v168, v112, v113
    v_cvt_pk_bf16_f32 v169, v114, v115
    v_cvt_pk_bf16_f32 v170, v116, v117
    v_cvt_pk_bf16_f32 v171, v118, v119
    v_cvt_pk_bf16_f32 v172, v120, v121
    buffer_load_dwordx4 a[136:139], v18, s[36:39], s86 offen offset:2048 sc1
    v_cvt_pk_bf16_f32 v173, v122, v123
    v_cvt_pk_bf16_f32 v174, v124, v125
    v_cvt_pk_bf16_f32 v175, v126, v127
    v_mul_f32 v208, s57, v96
    v_mul_f32 v209, s57, v97
    v_mul_f32 v210, s57, v98
    buffer_load_dwordx4 a[140:143], v18, s[36:39], s86 offen offset:3072 sc1
    v_mul_f32 v211, s57, v99
    v_min_f32 v208, 0, v208
    v_min_f32 v209, 0, v209
    v_min_f32 v210, 0, v210
    v_min_f32 v211, 0, v211
    v_exp_f32 v208, v208
    s_add_u32 s86, s86, 4096
    buffer_load_dwordx4 a[144:147], v18, s[36:39], s86 offen offset:0 sc1
    v_exp_f32 v209, v209
    v_exp_f32 v210, v210
    v_exp_f32 v211, v211
    v_max_f32 v96, 0, v96
    v_max_f32 v97, 0, v97
    v_max_f32 v98, 0, v98
    buffer_load_dwordx4 a[148:151], v18, s[36:39], s86 offen offset:1024 sc1
    v_max_f32 v99, 0, v99
    v_add_f32 v96, s58, v96
    v_add_f32 v97, s58, v97
    v_add_f32 v98, s58, v98
    v_add_f32 v99, s58, v99
    v_add_f32 v96, v96, v208
    buffer_load_dwordx4 a[152:155], v18, s[36:39], s86 offen offset:2048 sc1
    v_add_f32 v97, v97, v209
    v_add_f32 v98, v98, v210
    v_add_f32 v99, v99, v211
    v_mul_f32 v208, s57, v100
    v_mul_f32 v209, s57, v101
    v_mul_f32 v210, s57, v102
    buffer_load_dwordx4 a[156:159], v18, s[36:39], s86 offen offset:3072 sc1
    v_mul_f32 v211, s57, v103
    v_min_f32 v208, 0, v208
    v_min_f32 v209, 0, v209
    v_min_f32 v210, 0, v210
    v_min_f32 v211, 0, v211
    v_exp_f32 v208, v208
    s_add_u32 s86, s86, 4096
    buffer_load_dwordx4 a[160:163], v18, s[36:39], s86 offen offset:0 sc1
    v_exp_f32 v209, v209
    v_exp_f32 v210, v210
    v_exp_f32 v211, v211
    v_max_f32 v100, 0, v100
    v_max_f32 v101, 0, v101
    v_max_f32 v102, 0, v102
    buffer_load_dwordx4 a[164:167], v18, s[36:39], s86 offen offset:1024 sc1
    v_max_f32 v103, 0, v103
    v_add_f32 v100, s58, v100
    v_add_f32 v101, s58, v101
    v_add_f32 v102, s58, v102
    v_add_f32 v103, s58, v103
    v_add_f32 v100, v100, v208
    buffer_load_dwordx4 a[168:171], v18, s[36:39], s86 offen offset:2048 sc1
    v_add_f32 v101, v101, v209
    v_add_f32 v102, v102, v210
    v_add_f32 v103, v103, v211
    v_mul_f32 v208, s57, v104
    v_mul_f32 v209, s57, v105
    v_mul_f32 v210, s57, v106
    buffer_load_dwordx4 a[172:175], v18, s[36:39], s86 offen offset:3072 sc1
    v_mul_f32 v211, s57, v107
    v_min_f32 v208, 0, v208
    v_min_f32 v209, 0, v209
    v_min_f32 v210, 0, v210
    v_min_f32 v211, 0, v211
    v_exp_f32 v208, v208
    s_add_u32 s86, s86, 4096
    buffer_load_dwordx4 a[176:179], v18, s[36:39], s86 offen offset:0 sc1
    v_exp_f32 v209, v209
    v_exp_f32 v210, v210
    v_exp_f32 v211, v211
    v_max_f32 v104, 0, v104
    v_max_f32 v105, 0, v105
    v_max_f32 v106, 0, v106
    buffer_load_dwordx4 a[180:183], v18, s[36:39], s86 offen offset:1024 sc1
    v_max_f32 v107, 0, v107
    v_add_f32 v104, s58, v104
    v_add_f32 v105, s58, v105
    v_add_f32 v106, s58, v106
    v_add_f32 v107, s58, v107
    v_add_f32 v104, v104, v208
    buffer_load_dwordx4 a[184:187], v18, s[36:39], s86 offen offset:2048 sc1
    v_add_f32 v105, v105, v209
    v_add_f32 v106, v106, v210
    v_add_f32 v107, v107, v211
    v_mul_f32 v208, s57, v108
    v_mul_f32 v209, s57, v109
    v_mul_f32 v210, s57, v110
    buffer_load_dwordx4 a[188:191], v18, s[36:39], s86 offen offset:3072 sc1
    v_mul_f32 v211, s57, v111
    v_min_f32 v208, 0, v208
    v_min_f32 v209, 0, v209
    v_min_f32 v210, 0, v210
    v_min_f32 v211, 0, v211
    v_exp_f32 v208, v208
    s_xor_b32 s86, s5, 1
    s_lshl_b32 s86, s86, 14
    s_add_u32 s86, s86, s73
    buffer_load_dwordx4 a[192:195], v18, s[36:39], s86 offen offset:0 sc1
    v_exp_f32 v209, v209
    v_exp_f32 v210, v210
    v_exp_f32 v211, v211
    v_max_f32 v108, 0, v108
    v_max_f32 v109, 0, v109
    v_max_f32 v110, 0, v110
    buffer_load_dwordx4 a[196:199], v18, s[36:39], s86 offen offset:1024 sc1
    v_max_f32 v111, 0, v111
    v_add_f32 v108, s58, v108
    v_add_f32 v109, s58, v109
    v_add_f32 v110, s58, v110
    v_add_f32 v111, s58, v111
    v_add_f32 v108, v108, v208
    buffer_load_dwordx4 a[200:203], v18, s[36:39], s86 offen offset:2048 sc1
    v_add_f32 v109, v109, v209
    v_add_f32 v110, v110, v210
    v_add_f32 v111, v111, v211
    v_cvt_pk_bf16_f32 v160, v96, v97
    v_cvt_pk_bf16_f32 v161, v98, v99
    v_cvt_pk_bf16_f32 v162, v100, v101
    buffer_load_dwordx4 a[204:207], v18, s[36:39], s86 offen offset:3072 sc1
    v_cvt_pk_bf16_f32 v163, v102, v103
    v_cvt_pk_bf16_f32 v164, v104, v105
    v_cvt_pk_bf16_f32 v165, v106, v107
    v_cvt_pk_bf16_f32 v166, v108, v109
    v_cvt_pk_bf16_f32 v167, v110, v111
    v_mov_b32 v216, 0x3f803f80
    s_add_u32 s86, s86, 4096
    buffer_load_dwordx4 a[208:211], v18, s[36:39], s86 offen offset:0 sc1
    v_mov_b32 v217, 0x3f803f80
    v_mov_b32 v218, 0x3f803f80
    v_mov_b32 v219, 0x3f803f80
    v_lshlrev_b32 v208, 2, v1
    s_mul_i32 s52, s46, 2304
    s_add_u32 s52, s52, 52224
    buffer_load_dwordx4 a[212:215], v18, s[36:39], s86 offen offset:1024 sc1
    v_add_u32 v208, s52, v208
    v_mfma_f32_32x32x16_bf16 v[96:111], v[160:163], v[168:171], 0
    v_mfma_f32_32x32x16_bf16 v[112:127], v[216:219], v[160:163], 0
    v_mfma_f32_32x32x16_bf16 v[96:111], v[164:167], v[172:175], v[96:111]
    buffer_load_dwordx4 v3, s[20:23], s92 offen offset:1024 lds
    v_mfma_f32_32x32x16_bf16 v[112:127], v[216:219], v[164:167], v[112:127]
    s_nop 9
    v_cndmask_b32 v6, v96, v104, s[60:61]
    buffer_load_dwordx4 a[216:219], v18, s[36:39], s86 offen offset:2048 sc1
    v_cndmask_b32 v7, v97, v105, s[60:61]
    v_cndmask_b32 v8, v98, v106, s[60:61]
    v_cndmask_b32 v62, v99, v107, s[60:61]
    v_cndmask_b32 v63, v100, v108, s[60:61]
    v_cndmask_b32 v236, v101, v109, s[60:61]
    v_cndmask_b32 v237, v102, v110, s[60:61]
    buffer_load_dwordx4 a[220:223], v18, s[36:39], s86 offen offset:3072 sc1
    v_cndmask_b32 v244, v103, v111, s[60:61]
    v_mov_b32 v245, v112
    ds_write_b32 v208, v6 offset:0
    ds_write_b32 v208, v7 offset:256
    ds_write_b32 v208, v8 offset:512
    ds_write_b32 v208, v62 offset:768
    ds_write_b32 v208, v63 offset:1024
    ds_write_b32 v208, v236 offset:1280
    ds_write_b32 v208, v237 offset:1536
    ds_write_b32 v208, v244 offset:1792
    ds_write_b32 v208, v245 offset:2048
    s_waitcnt lgkmcnt(0)
    s_barrier
    v_lshlrev_b32 v208, 2, v1
    s_xor_b32 s52, s46, 1
    s_mul_i32 s52, s52, 2304
    s_add_u32 s52, s52, 52224
    v_add_u32 v208, s52, v208
    ds_read_b32 v209, v208 offset:0
    ds_read_b32 v210, v208 offset:256
    ds_read_b32 v211, v208 offset:512
    ds_read_b32 v212, v208 offset:768
    ds_read_b32 v213, v208 offset:1024
    ds_read_b32 v214, v208 offset:1280
    ds_read_b32 v215, v208 offset:1536
    ds_read_b32 v216, v208 offset:1792
    ds_read_b32 v217, v208 offset:2048
    s_waitcnt lgkmcnt(0)
    v_add_f32 v6, v6, v209
    v_add_f32 v7, v7, v210
    v_add_f32 v8, v8, v211
    v_add_f32 v62, v62, v212
    v_add_f32 v63, v63, v213
    v_add_f32 v236, v236, v214
    v_add_f32 v237, v237, v215
    v_add_f32 v244, v244, v216
    v_add_f32 v245, v245, v217
    v_cmp_ne_u32 vcc, s47, v247
    s_mov_b32 s99, 0
    s_nop 3
    s_cbranch_vccz L_zfok_6
L_zf_5:
    s_sleep 2
    buffer_load_dword v247, v246, s[36:39], s98 offen sc1
    s_waitcnt vmcnt(0)
    v_cmp_ne_u32 vcc, s47, v247
    s_add_u32 s99, s99, 1
    s_nop 3
    s_cbranch_vccz L_zfok_6
    s_cmp_lt_u32 s99, 0x40000
    s_cbranch_scc1 L_zf_5
L_zfok_6:
    v_lshlrev_b32 v250, 2, v1
    s_lshl_b32 s96, s45, 1
    s_add_u32 s96, s96, s63
    s_lshl_b32 s97, s96, 7
    s_add_u32 s97, s97, 163840
    s_lshl_b32 s96, s96, 11
    s_add_u32 s96, s96, 131072
    s_cmp_eq_u32 s62, 0
    s_cselect_b32 s96, s96, 0x7f000000
    s_cselect_b32 s97, s97, 0x7f000000
    buffer_atomic_add_f32 v6, v250, s[36:39], s96 offen offset:0
    buffer_atomic_add_f32 v7, v250, s[36:39], s96 offen offset:256
    buffer_atomic_add_f32 v8, v250, s[36:39], s96 offen offset:512
    buffer_atomic_add_f32 v62, v250, s[36:39], s96 offen offset:768
    buffer_atomic_add_f32 v63, v250, s[36:39], s96 offen offset:1024
    buffer_atomic_add_f32 v236, v250, s[36:39], s96 offen offset:1280
    buffer_atomic_add_f32 v237, v250, s[36:39], s96 offen offset:1536
    buffer_atomic_add_f32 v244, v250, s[36:39], s96 offen offset:1792
    s_mov_b32 exec_hi, 0
    buffer_atomic_add_f32 v245, v250, s[36:39], s97 offen
    s_mov_b32 exec_hi, -1
    s_waitcnt vmcnt(33)
    v_mfma_f32_32x32x16_bf16 v[64:79], a[128:131], v[28:31], 0
    ds_read_b128 v[44:47], v22 offset:0
    ds_read_b128 v[48:51], v26 offset:0
    v_mfma_f32_32x32x16_bf16 v[80:95], a[128:131], v[32:35], 0
    s_add_u32 s86, s86, 4096
    buffer_load_dwordx4 a[224:227], v18, s[36:39], s86 offen offset:0 sc1
    s_waitcnt vmcnt(33)
    v_mfma_f32_32x32x16_bf16 v[64:79], a[132:135], v[36:39], v[64:79]
    ds_read_b128 v[28:31], v23 offset:0
    ds_read_b128 v[32:35], v27 offset:0
    v_mul_f32 v240, s57, v176
    v_mul_f32 v241, s57, v177
    v_mfma_f32_32x32x16_bf16 v[80:95], a[132:135], v[40:43], v[80:95]
    buffer_load_dwordx4 a[228:231], v18, s[36:39], s86 offen offset:1024 sc1
    v_mul_f32 v242, s57, v178
    v_mul_f32 v243, s57, v179
    v_min_f32 v240, 0, v240
    s_waitcnt vmcnt(33)
    s_waitcnt lgkmcnt(2)
    v_mfma_f32_32x32x16_bf16 v[64:79], a[136:139], v[44:47], v[64:79]
    ds_read_b128 v[36:39], v20 offset:8192
    ds_read_b128 v[40:43], v24 offset:8192
    buffer_load_dwordx4 v4, s[20:23], s92 offen offset:2048 lds
    v_min_f32 v241, 0, v241
    v_min_f32 v242, 0, v242
    v_min_f32 v243, 0, v243
    v_mfma_f32_32x32x16_bf16 v[80:95], a[136:139], v[48:51], v[80:95]
    buffer_load_dwordx4 a[232:235], v18, s[36:39], s86 offen offset:2048 sc1
    v_exp_f32 v240, v240
    v_exp_f32 v241, v241
    s_waitcnt vmcnt(34)
    s_waitcnt lgkmcnt(2)
    v_mfma_f32_32x32x16_bf16 v[64:79], a[140:143], v[28:31], v[64:79]
    ds_read_b128 v[44:47], v21 offset:8192
    ds_read_b128 v[48:51], v25 offset:8192
    buffer_load_dwordx4 v5, s[20:23], s92 offen offset:3072 lds
    v_exp_f32 v242, v242
    v_mfma_f32_32x32x16_bf16 v[80:95], a[140:143], v[32:35], v[80:95]
    buffer_load_dwordx4 a[236:239], v18, s[36:39], s86 offen offset:3072 sc1
    v_exp_f32 v243, v243
    v_max_f32 v176, 0, v176
    v_max_f32 v177, 0, v177
    v_max_f32 v178, 0, v178
    s_waitcnt vmcnt(35)
    s_waitcnt lgkmcnt(2)
    v_mfma_f32_32x32x16_bf16 v[64:79], a[144:147], v[36:39], v[64:79]
    ds_read_b128 v[28:31], v22 offset:8192
    ds_read_b128 v[32:35], v26 offset:8192
    v_max_f32 v179, 0, v179
    v_add_f32 v176, s58, v176
    v_mfma_f32_32x32x16_bf16 v[80:95], a[144:147], v[40:43], v[80:95]
    s_add_u32 s86, s86, 4096
    buffer_load_dwordx4 a[240:243], v18, s[36:39], s86 offen offset:0 sc1
    v_add_f32 v177, s58, v177
    v_add_f32 v178, s58, v178
    v_add_f32 v179, s58, v179
    s_waitcnt vmcnt(35)
    s_waitcnt lgkmcnt(2)
    v_mfma_f32_32x32x16_bf16 v[64:79], a[148:151], v[44:47], v[64:79]
    ds_read_b128 v[36:39], v23 offset:8192
    ds_read_b128 v[40:43], v27 offset:8192
    s_add_u32 m0, m0, 4096
    s_nop 0
    buffer_load_dwordx4 v2, s[20:23], s93 offen offset:0 lds
    v_add_f32 v176, v176, v240
    v_mfma_f32_32x32x16_bf16 v[80:95], a[148:151], v[48:51], v[80:95]
    buffer_load_dwordx4 a[244:247], v18, s[36:39], s86 offen offset:1024 sc1
    v_add_f32 v177, v177, v241
    v_add_f32 v178, v178, v242
    v_add_f32 v179, v179, v243
    v_mul_f32 v240, s57, v180
    s_waitcnt vmcnt(36)
    s_waitcnt lgkmcnt(2)
    v_mfma_f32_32x32x16_bf16 v[64:79], a[152:155], v[28:31], v[64:79]
    ds_read_b128 v[44:47], v20 offset:16384
    ds_read_b128 v[48:51], v24 offset:16384
    buffer_load_dwordx4 v3, s[20:23], s93 offen offset:1024 lds
    v_mul_f32 v241, s57, v181
    v_mul_f32 v242, s57, v182
    v_mfma_f32_32x32x16_bf16 v[80:95], a[152:155], v[32:35], v[80:95]
    buffer_load_dwordx4 a[248:251], v18, s[36:39], s86 offen offset:2048 sc1
    v_mul_f32 v243, s57, v183
    v_min_f32 v240, 0, v240
    v_min_f32 v241, 0, v241
    s_waitcnt vmcnt(37)
    s_waitcnt lgkmcnt(2)
    v_mfma_f32_32x32x16_bf16 v[64:79], a[156:159], v[36:39], v[64:79]
    ds_read_b128 v[28:31], v21 offset:16384
    ds_read_b128 v[32:35], v25 offset:16384
    v_min_f32 v242, 0, v242
    v_min_f32 v243, 0, v243
    v_exp_f32 v240, v240
    v_mfma_f32_32x32x16_bf16 v[80:95], a[156:159], v[40:43], v[80:95]
    buffer_load_dwordx4 a[252:255], v18, s[36:39], s86 offen offset:3072 sc1
    v_exp_f32 v241, v241
    v_exp_f32 v242, v242
    s_waitcnt vmcnt(37)
    s_waitcnt lgkmcnt(2)
    v_mfma_f32_32x32x16_bf16 v[64:79], a[160:163], v[44:47], v[64:79]
    ds_read_b128 v[36:39], v22 offset:16384
    ds_read_b128 v[40:43], v26 offset:16384
    buffer_load_dwordx4 v4, s[20:23], s93 offen offset:2048 lds
    v_exp_f32 v243, v243
    v_mfma_f32_32x32x16_bf16 v[80:95], a[160:163], v[48:51], v[80:95]
    s_xor_b32 s86, s5, 2
    s_lshl_b32 s86, s86, 14
    s_add_u32 s86, s86, s73
    buffer_load_dwordx4 a[128:131], v18, s[36:39], s86 offen offset:0 sc1
    v_max_f32 v180, 0, v180
    v_max_f32 v181, 0, v181
    v_max_f32 v182, 0, v182
    v_max_f32 v183, 0, v183
    s_waitcnt vmcnt(38)
    s_waitcnt lgkmcnt(2)
    v_mfma_f32_32x32x16_bf16 v[64:79], a[164:167], v[28:31], v[64:79]
    ds_read_b128 v[44:47], v23 offset:16384
    ds_read_b128 v[48:51], v27 offset:16384
    buffer_load_dwordx4 v5, s[20:23], s93 offen offset:3072 lds
    v_add_f32 v180, s58, v180
    v_add_f32 v181, s58, v181
    v_mfma_f32_32x32x16_bf16 v[80:95], a[164:167], v[32:35], v[80:95]
    buffer_load_dwordx4 a[132:135], v18, s[36:39], s86 offen offset:1024 sc1
    v_add_f32 v182, s58, v182
    v_add_f32 v183, s58, v183
    v_add_f32 v180, v180, v240
    s_waitcnt vmcnt(39)
    s_waitcnt lgkmcnt(2)
    v_mfma_f32_32x32x16_bf16 v[64:79], a[168:171], v[36:39], v[64:79]
    ds_read_b128 v[28:31], v20 offset:24576
    ds_read_b128 v[32:35], v24 offset:24576
    v_add_f32 v181, v181, v241
    v_add_f32 v182, v182, v242
    v_mfma_f32_32x32x16_bf16 v[80:95], a[168:171], v[40:43], v[80:95]
    buffer_load_dwordx4 a[136:139], v18, s[36:39], s86 offen offset:2048 sc1
    v_add_f32 v183, v183, v243
    v_mul_f32 v240, s57, v184
    v_mul_f32 v241, s57, v185
    s_waitcnt vmcnt(39)
    s_waitcnt lgkmcnt(2)
    v_mfma_f32_32x32x16_bf16 v[64:79], a[172:175], v[44:47], v[64:79]
    ds_read_b128 v[36:39], v21 offset:24576
    ds_read_b128 v[40:43], v25 offset:24576
    v_mul_f32 v242, s57, v186
    v_mul_f32 v243, s57, v187
    v_mfma_f32_32x32x16_bf16 v[80:95], a[172:175], v[48:51], v[80:95]
    buffer_load_dwordx4 a[140:143], v18, s[36:39], s86 offen offset:3072 sc1
    v_min_f32 v240, 0, v240
    v_min_f32 v241, 0, v241
    v_min_f32 v242, 0, v242
    s_waitcnt vmcnt(39)
    s_waitcnt lgkmcnt(2)
    v_mfma_f32_32x32x16_bf16 v[64:79], a[176:179], v[28:31], v[64:79]
    ds_read_b128 v[44:47], v22 offset:24576
    ds_read_b128 v[48:51], v26 offset:24576
    v_min_f32 v243, 0, v243
    v_exp_f32 v240, v240
    v_exp_f32 v241, v241
    v_mfma_f32_32x32x16_bf16 v[80:95], a[176:179], v[32:35], v[80:95]
    s_add_u32 s86, s86, 4096
    buffer_load_dwordx4 a[144:147], v18, s[36:39], s86 offen offset:0 sc1
    v_exp_f32 v242, v242
    v_exp_f32 v243, v243
    s_waitcnt vmcnt(39)
    s_waitcnt lgkmcnt(2)
    v_mfma_f32_32x32x16_bf16 v[64:79], a[180:183], v[36:39], v[64:79]
    ds_read_b128 v[28:31], v23 offset:24576
    ds_read_b128 v[32:35], v27 offset:24576
    v_max_f32 v184, 0, v184
    v_max_f32 v185, 0, v185
    v_mfma_f32_32x32x16_bf16 v[80:95], a[180:183], v[40:43], v[80:95]
    buffer_load_dwordx4 a[148:151], v18, s[36:39], s86 offen offset:1024 sc1
    v_max_f32 v186, 0, v186
    v_max_f32 v187, 0, v187
    v_add_f32 v184, s58, v184
    s_barrier
    s_waitcnt vmcnt(39)
    s_waitcnt lgkmcnt(2)
    v_mfma_f32_32x32x16_bf16 v[64:79], a[184:187], v[44:47], v[64:79]
    v_subrev_u32 v20, 131072, v20
    v_subrev_u32 v21, 131072, v21
    v_subrev_u32 v22, 131072, v22
    v_subrev_u32 v23, 131072, v23
    v_subrev_u32 v24, 131072, v24
    v_subrev_u32 v25, 131072, v25
    v_subrev_u32 v26, 131072, v26
    v_subrev_u32 v27, 131072, v27
    ds_read_b128 v[36:39], v20 offset:0
    ds_read_b128 v[40:43], v24 offset:0
    v_mfma_f32_32x32x16_bf16 v[80:95], a[184:187], v[48:51], v[80:95]
    buffer_load_dwordx4 a[152:155], v18, s[36:39], s86 offen offset:2048 sc1
    v_add_f32 v185, s58, v185
    v_add_f32 v186, s58, v186
    v_add_f32 v187, s58, v187
    v_add_f32 v184, v184, v240
    v_add_f32 v185, v185, v241
    s_waitcnt vmcnt(39)
    s_waitcnt lgkmcnt(2)
    v_mfma_f32_32x32x16_bf16 v[64:79], a[188:191], v[28:31], v[64:79]
    ds_read_b128 v[44:47], v21 offset:0
    ds_read_b128 v[48:51], v25 offset:0
    s_xor_b32 s92, s5, 3
    s_lshl_b32 s92, s92, 9
    s_add_u32 s92, s92, s74
    s_add_u32 s93, s92, 131072
    s_lshl_b32 s94, s72, 1
    s_add_u32 m0, s94, 98304
    s_nop 0
    buffer_load_dwordx4 v2, s[20:23], s92 offen offset:0 lds
    v_mfma_f32_32x32x16_bf16 v[80:95], a[188:191], v[32:35], v[80:95]
    buffer_load_dwordx4 a[156:159], v18, s[36:39], s86 offen offset:3072 sc1
    v_add_f32 v186, v186, v242
    v_add_f32 v187, v187, v243
    v_mul_f32 v240, s57, v188
    v_mul_f32 v241, s57, v189
    v_mul_f32 v242, s57, v190
    s_waitcnt vmcnt(40)
    s_waitcnt lgkmcnt(2)
    v_mfma_f32_32x32x16_bf16 v[64:79], a[192:195], v[36:39], v[64:79]
    ds_read_b128 v[28:31], v22 offset:0
    ds_read_b128 v[32:35], v26 offset:0
    buffer_load_dwordx4 v3, s[20:23], s92 offen offset:1024 lds
    v_mul_f32 v243, s57, v191
    v_min_f32 v240, 0, v240
    v_mfma_f32_32x32x16_bf16 v[80:95], a[192:195], v[40:43], v[80:95]
    s_add_u32 s86, s86, 4096
    buffer_load_dwordx4 a[160:163], v18, s[36:39], s86 offen offset:0 sc1
    v_min_f32 v241, 0, v241
    v_min_f32 v242, 0, v242
    v_min_f32 v243, 0, v243
    s_waitcnt vmcnt(41)
    s_waitcnt lgkmcnt(2)
    v_mfma_f32_32x32x16_bf16 v[64:79], a[196:199], v[44:47], v[64:79]
    ds_read_b128 v[36:39], v23 offset:0
    ds_read_b128 v[40:43], v27 offset:0
    v_exp_f32 v240, v240
    v_exp_f32 v241, v241
    v_mfma_f32_32x32x16_bf16 v[80:95], a[196:199], v[48:51], v[80:95]
    buffer_load_dwordx4 a[164:167], v18, s[36:39], s86 offen offset:1024 sc1
    v_exp_f32 v242, v242
    v_exp_f32 v243, v243
    v_max_f32 v188, 0, v188
    s_waitcnt vmcnt(41)
    s_waitcnt lgkmcnt(2)
    v_mfma_f32_32x32x16_bf16 v[64:79], a[200:203], v[28:31], v[64:79]
    ds_read_b128 v[44:47], v20 offset:8192
    ds_read_b128 v[48:51], v24 offset:8192
    buffer_load_dwordx4 v4, s[20:23], s92 offen offset:2048 lds
    v_max_f32 v189, 0, v189
    v_max_f32 v190, 0, v190
    v_mfma_f32_32x32x16_bf16 v[80:95], a[200:203], v[32:35], v[80:95]
    buffer_load_dwordx4 a[168:171], v18, s[36:39], s86 offen offset:2048 sc1
    v_max_f32 v191, 0, v191
    v_add_f32 v188, s58, v188
    v_add_f32 v189, s58, v189
    s_waitcnt vmcnt(42)
    s_waitcnt lgkmcnt(2)
    v_mfma_f32_32x32x16_bf16 v[64:79], a[204:207], v[36:39], v[64:79]
    ds_read_b128 v[28:31], v21 offset:8192
    ds_read_b128 v[32:35], v25 offset:8192
    buffer_load_dwordx4 v5, s[20:23], s92 offen offset:3072 lds
    v_add_f32 v190, s58, v190
    v_add_f32 v191, s58, v191
    v_mfma_f32_32x32x16_bf16 v[80:95], a[204:207], v[40:43], v[80:95]
    buffer_load_dwordx4 a[172:175], v18, s[36:39], s86 offen offset:3072 sc1
    v_add_f32 v188, v188, v240
    v_add_f32 v189, v189, v241
    v_add_f32 v190, v190, v242
    s_waitcnt vmcnt(43)
    s_waitcnt lgkmcnt(2)
    v_mfma_f32_32x32x16_bf16 v[64:79], a[208:211], v[44:47], v[64:79]
    ds_read_b128 v[36:39], v22 offset:8192
    ds_read_b128 v[40:43], v26 offset:8192
    v_add_f32 v191, v191, v243
    v_cvt_pk_bf16_f32 v52, v176, v177
    v_mfma_f32_32x32x16_bf16 v[80:95], a[208:211], v[48:51], v[80:95]
    s_add_u32 s86, s86, 4096
    buffer_load_dwordx4 a[176:179], v18, s[36:39], s86 offen offset:0 sc1
    v_cvt_pk_bf16_f32 v53, v178, v179
    v_cvt_pk_bf16_f32 v54, v180, v181
    v_cvt_pk_bf16_f32 v55, v182, v183
    s_waitcnt vmcnt(43)
    s_waitcnt lgkmcnt(2)
    v_mfma_f32_32x32x16_bf16 v[64:79], a[212:215], v[28:31], v[64:79]
    ds_read_b128 v[44:47], v23 offset:8192
    ds_read_b128 v[48:51], v27 offset:8192
    s_add_u32 m0, m0, 4096
    s_nop 0
    buffer_load_dwordx4 v2, s[20:23], s93 offen offset:0 lds
    v_cvt_pk_bf16_f32 v56, v184, v185
    v_mfma_f32_32x32x16_bf16 v[80:95], a[212:215], v[32:35], v[80:95]
    buffer_load_dwordx4 a[180:183], v18, s[36:39], s86 offen offset:1024 sc1
    v_cvt_pk_bf16_f32 v57, v186, v187
    v_cvt_pk_bf16_f32 v58, v188, v189
    v_cvt_pk_bf16_f32 v59, v190, v191
    s_waitcnt vmcnt(43)
    s_waitcnt lgkmcnt(2)
    v_mfma_f32_32x32x16_bf16 v[64:79], a[216:219], v[36:39], v[64:79]
    ds_read_b128 v[28:31], v20 offset:16384
    ds_read_b128 v[32:35], v24 offset:16384
    buffer_load_dwordx4 v3, s[20:23], s93 offen offset:1024 lds
    v_mul_f32 v240, v128, v128
    v_mfma_f32_32x32x16_bf16 v[80:95], a[216:219], v[40:43], v[80:95]
    buffer_load_dwordx4 a[184:187], v18, s[36:39], s86 offen offset:2048 sc1
    v_mul_f32 v241, v129, v129
    v_mul_f32 v242, v130, v130
    s_waitcnt vmcnt(44)
    s_waitcnt lgkmcnt(2)
    v_mfma_f32_32x32x16_bf16 v[64:79], a[220:223], v[44:47], v[64:79]
    ds_read_b128 v[36:39], v21 offset:16384
    ds_read_b128 v[40:43], v25 offset:16384
    v_mul_f32 v243, v131, v131
    v_mfma_f32_32x32x16_bf16 v[80:95], a[220:223], v[48:51], v[80:95]
    buffer_load_dwordx4 a[188:191], v18, s[36:39], s86 offen offset:3072 sc1
    v_fma_f32 v240, v240, s56, v17
    v_fma_f32 v241, v241, s56, v17
    s_waitcnt vmcnt(35)
    s_waitcnt lgkmcnt(2)
    v_mfma_f32_32x32x16_bf16 v[64:79], a[224:227], v[28:31], v[64:79]
    ds_read_b128 v[44:47], v22 offset:16384
    ds_read_b128 v[48:51], v26 offset:16384
    buffer_load_dwordx4 v4, s[20:23], s93 offen offset:2048 lds
    v_mfma_f32_32x32x16_bf16 v[80:95], a[224:227], v[32:35], v[80:95]
    s_xor_b32 s86, s5, 3
    s_lshl_b32 s86, s86, 14
    s_add_u32 s86, s86, s73
    buffer_load_dwordx4 a[192:195], v18, s[36:39], s86 offen offset:0 sc1
    v_fma_f32 v242, v242, s56, v17
    v_fma_f32 v243, v243, s56, v17
    s_waitcnt vmcnt(36)
    s_waitcnt lgkmcnt(2)
    v_mfma_f32_32x32x16_bf16 v[64:79], a[228:231], v[36:39], v[64:79]
    ds_read_b128 v[28:31], v23 offset:16384
    ds_read_b128 v[32:35], v27 offset:16384
    buffer_load_dwordx4 v5, s[20:23], s93 offen offset:3072 lds
    v_mul_f32 v240, v128, v240
    v_mfma_f32_32x32x16_bf16 v[80:95], a[228:231], v[40:43], v[80:95]
    buffer_load_dwordx4 a[196:199], v18, s[36:39], s86 offen offset:1024 sc1
    v_mul_f32 v241, v129, v241
    v_mul_f32 v242, v130, v242
    s_waitcnt vmcnt(36)
    s_waitcnt lgkmcnt(2)
    v_mfma_f32_32x32x16_bf16 v[64:79], a[232:235], v[44:47], v[64:79]
    ds_read_b128 v[36:39], v20 offset:24576
    ds_read_b128 v[40:43], v24 offset:24576
    v_mul_f32 v243, v131, v243
    v_mfma_f32_32x32x16_bf16 v[80:95], a[232:235], v[48:51], v[80:95]
    buffer_load_dwordx4 a[200:203], v18, s[36:39], s86 offen offset:2048 sc1
    v_exp_f32 v240, v240
    s_waitcnt vmcnt(35)
    s_waitcnt lgkmcnt(2)
    v_mfma_f32_32x32x16_bf16 v[64:79], a[236:239], v[28:31], v[64:79]
    ds_read_b128 v[44:47], v21 offset:24576
    ds_read_b128 v[48:51], v25 offset:24576
    v_exp_f32 v241, v241
    v_mfma_f32_32x32x16_bf16 v[80:95], a[236:239], v[32:35], v[80:95]
    buffer_load_dwordx4 a[204:207], v18, s[36:39], s86 offen offset:3072 sc1
    v_exp_f32 v242, v242
    v_exp_f32 v243, v243
    s_waitcnt vmcnt(35)
    s_waitcnt lgkmcnt(2)
    v_mfma_f32_32x32x16_bf16 v[64:79], a[240:243], v[36:39], v[64:79]
    ds_read_b128 v[28:31], v22 offset:24576
    ds_read_b128 v[32:35], v26 offset:24576
    v_add_f32 v240, 1.0, v240
    v_mfma_f32_32x32x16_bf16 v[80:95], a[240:243], v[40:43], v[80:95]
    s_add_u32 s86, s86, 4096
    buffer_load_dwordx4 a[208:211], v18, s[36:39], s86 offen offset:0 sc1
    v_add_f32 v241, 1.0, v241
    v_add_f32 v242, 1.0, v242
    s_waitcnt vmcnt(34)
    s_waitcnt lgkmcnt(2)
    v_mfma_f32_32x32x16_bf16 v[64:79], a[244:247], v[44:47], v[64:79]
    ds_read_b128 v[36:39], v23 offset:24576
    ds_read_b128 v[40:43], v27 offset:24576
    v_add_f32 v243, 1.0, v243
    v_mfma_f32_32x32x16_bf16 v[80:95], a[244:247], v[48:51], v[80:95]
    buffer_load_dwordx4 a[212:215], v18, s[36:39], s86 offen offset:1024 sc1
    v_rcp_f32 v240, v240
    s_waitcnt vmcnt(29)
    s_barrier
    s_lshl_b32 s96, s45, 5
    s_add_u32 s96, s96, s44
    s_lshl_b32 s96, s96, 7
    s_add_u32 s96, s96, 196608
    s_cmp_eq_u32 s46, 0
    s_cselect_b32 s96, s96, 0x7f000000
    v_mov_b32 v248, s47
    v_mov_b32 v249, 0
    s_mov_b64 exec, 1
    buffer_store_dword v248, v249, s[36:39], s96 offen sc1
    s_mov_b64 exec, -1
    s_waitcnt lgkmcnt(2)
    v_mfma_f32_32x32x16_bf16 v[64:79], a[248:251], v[28:31], v[64:79]
    v_add_u32 v20, 65536, v20
    v_add_u32 v21, 65536, v21
    v_add_u32 v22, 65536, v22
    v_add_u32 v23, 65536, v23
    v_add_u32 v24, 65536, v24
    v_add_u32 v25, 65536, v25
    v_add_u32 v26, 65536, v26
    v_add_u32 v27, 65536, v27
    ds_read_b128 v[44:47], v20 offset:0
    ds_read_b128 v[48:51], v24 offset:0
    v_rcp_f32 v241, v241
    v_mfma_f32_32x32x16_bf16 v[80:95], a[248:251], v[32:35], v[80:95]
    buffer_load_dwordx4 a[216:219], v18, s[36:39], s86 offen offset:2048 sc1
    v_rcp_f32 v242, v242
    v_rcp_f32 v243, v243
    v_and_b32 v218, 15, v1
    s_and_b32 s96, s46, 1
    s_lshl_b32 s96, s96, 4
    v_add_u32 v218, s96, v218
    v_and_b32 v219, 0x13, v218
    v_bfe_u32 v220, v218, 2, 1
    s_waitcnt lgkmcnt(2)
    v_mfma_f32_32x32x16_bf16 v[64:79], a[252:255], v[36:39], v[64:79]
    ds_read_b128 v[28:31], v21 offset:0
    ds_read_b128 v[32:35], v25 offset:0
    s_xor_b32 s92, s5, 4
    s_lshl_b32 s92, s92, 9
    s_add_u32 s92, s92, s74
    s_add_u32 s93, s92, 131072
    s_lshl_b32 s94, s72, 1
    s_add_u32 m0, s94, 131072
    s_nop 0
    buffer_load_dwordx4 v2, s[20:23], s92 offen offset:0 lds
    v_mul_f32 v128, v128, v240
    v_mfma_f32_32x32x16_bf16 v[80:95], a[252:255], v[40:43], v[80:95]
    buffer_load_dwordx4 a[220:223], v18, s[36:39], s86 offen offset:3072 sc1
    v_mul_f32 v129, v129, v241
    v_lshl_or_b32 v219, v220, 3, v219
    v_bfe_u32 v220, v218, 3, 1
    v_lshl_or_b32 v219, v220, 2, v219
    v_lshlrev_b32 v219, 10, v219
    v_lshrrev_b32 v220, 4, v1
    v_lshl_add_u32 v19, v220, 3, v219
    s_waitcnt lgkmcnt(2)
    v_mfma_f32_32x32x16_bf16 v[64:79], a[128:131], v[44:47], v[64:79]
    ds_read_b128 v[36:39], v22 offset:0
    ds_read_b128 v[40:43], v26 offset:0
    buffer_load_dwordx4 v3, s[20:23], s92 offen offset:1024 lds
    v_mul_f32 v130, v130, v242
    v_mul_f32 v131, v131, v243
    v_mfma_f32_32x32x16_bf16 v[80:95], a[128:131], v[48:51], v[80:95]
    s_add_u32 s86, s86, 4096
    buffer_load_dwordx4 a[224:227], v18, s[36:39], s86 offen offset:0 sc1
    v_mul_f32 v240, v132, v132
    s_lshl_b32 s88, s44, 16
    s_lshr_b32 s96, s46, 1
    s_lshl_b32 s96, s96, 15
    s_add_u32 s88, s88, s96
    s_lshl_b32 s96, s45, 7
    s_add_u32 s88, s88, s96
    s_waitcnt vmcnt(34)
    s_waitcnt lgkmcnt(2)
    v_mfma_f32_32x32x16_bf16 v[64:79], a[132:135], v[28:31], v[64:79]
    ds_read_b128 v[44:47], v23 offset:0
    ds_read_b128 v[48:51], v27 offset:0
    v_mul_f32 v241, v133, v133
    v_mul_f32 v242, v134, v134
    v_mfma_f32_32x32x16_bf16 v[80:95], a[132:135], v[32:35], v[80:95]
    buffer_load_dwordx4 a[228:231], v18, s[36:39], s86 offen offset:1024 sc1
    s_mul_i32 s87, s44, 180224
    s_mul_i32 s96, s46, 45056
    s_add_u32 s87, s87, s96
    s_add_u32 s87, s87, 5242880
    s_mov_b32 s95, s87
    s_waitcnt vmcnt(34)
    s_waitcnt lgkmcnt(2)
    v_mfma_f32_32x32x16_bf16 v[64:79], a[136:139], v[36:39], v[64:79]
    ds_read_b128 v[28:31], v20 offset:8192
    ds_read_b128 v[32:35], v24 offset:8192
    buffer_load_dwordx4 v4, s[20:23], s92 offen offset:2048 lds
    v_mul_f32 v243, v135, v135
    v_mfma_f32_32x32x16_bf16 v[80:95], a[136:139], v[40:43], v[80:95]
    buffer_load_dwordx4 a[232:235], v18, s[36:39], s86 offen offset:2048 sc1
    v_fma_f32 v240, v240, s56, v17
    v_fma_f32 v241, v241, s56, v17
    s_waitcnt vmcnt(35)
    s_waitcnt lgkmcnt(2)
    v_mfma_f32_32x32x16_bf16 v[64:79], a[140:143], v[44:47], v[64:79]
    ds_read_b128 v[36:39], v21 offset:8192
    ds_read_b128 v[40:43], v25 offset:8192
    buffer_load_dwordx4 v5, s[20:23], s92 offen offset:3072 lds
    v_fma_f32 v242, v242, s56, v17
    v_mfma_f32_32x32x16_bf16 v[80:95], a[140:143], v[48:51], v[80:95]
    buffer_load_dwordx4 a[236:239], v18, s[36:39], s86 offen offset:3072 sc1
    v_fma_f32 v243, v243, s56, v17
    v_mul_f32 v240, v132, v240
    s_waitcnt vmcnt(36)
    s_waitcnt lgkmcnt(2)
    v_mfma_f32_32x32x16_bf16 v[64:79], a[144:147], v[28:31], v[64:79]
    ds_read_b128 v[44:47], v22 offset:8192
    ds_read_b128 v[48:51], v26 offset:8192
    v_mul_f32 v241, v133, v241
    v_mfma_f32_32x32x16_bf16 v[80:95], a[144:147], v[32:35], v[80:95]
    s_add_u32 s86, s86, 4096
    buffer_load_dwordx4 a[240:243], v18, s[36:39], s86 offen offset:0 sc1
    v_mul_f32 v242, v134, v242
    s_waitcnt vmcnt(36)
    s_waitcnt lgkmcnt(2)
    v_mfma_f32_32x32x16_bf16 v[64:79], a[148:151], v[36:39], v[64:79]
    ds_read_b128 v[28:31], v23 offset:8192
    ds_read_b128 v[32:35], v27 offset:8192
    s_add_u32 m0, m0, 4096
    s_nop 0
    buffer_load_dwordx4 v2, s[20:23], s93 offen offset:0 lds
    v_mul_f32 v243, v135, v243
    v_mfma_f32_32x32x16_bf16 v[80:95], a[148:151], v[40:43], v[80:95]
    buffer_load_dwordx4 a[244:247], v18, s[36:39], s86 offen offset:1024 sc1
    v_exp_f32 v240, v240
    v_exp_f32 v241, v241
    s_waitcnt vmcnt(37)
    s_waitcnt lgkmcnt(2)
    v_mfma_f32_32x32x16_bf16 v[64:79], a[152:155], v[44:47], v[64:79]
    ds_read_b128 v[36:39], v20 offset:16384
    ds_read_b128 v[40:43], v24 offset:16384
    buffer_load_dwordx4 v3, s[20:23], s93 offen offset:1024 lds
    v_exp_f32 v242, v242
    v_mfma_f32_32x32x16_bf16 v[80:95], a[152:155], v[48:51], v[80:95]
    buffer_load_dwordx4 a[248:251], v18, s[36:39], s86 offen offset:2048 sc1
    v_exp_f32 v243, v243
    s_waitcnt vmcnt(37)
    s_waitcnt lgkmcnt(2)
    v_mfma_f32_32x32x16_bf16 v[64:79], a[156:159], v[28:31], v[64:79]
    ds_read_b128 v[44:47], v21 offset:16384
    ds_read_b128 v[48:51], v25 offset:16384
    v_add_f32 v240, 1.0, v240
    v_mfma_f32_32x32x16_bf16 v[80:95], a[156:159], v[32:35], v[80:95]
    buffer_load_dwordx4 a[252:255], v18, s[36:39], s86 offen offset:3072 sc1
    v_add_f32 v241, 1.0, v241
    v_add_f32 v242, 1.0, v242
    s_waitcnt vmcnt(36)
    s_waitcnt lgkmcnt(2)
    v_mfma_f32_32x32x16_bf16 v[64:79], a[160:163], v[36:39], v[64:79]
    ds_read_b128 v[28:31], v22 offset:16384
    ds_read_b128 v[32:35], v26 offset:16384
    buffer_load_dwordx4 v4, s[20:23], s93 offen offset:2048 lds
    v_add_f32 v243, 1.0, v243
    v_mfma_f32_32x32x16_bf16 v[80:95], a[160:163], v[40:43], v[80:95]
    s_xor_b32 s86, s5, 4
    s_lshl_b32 s86, s86, 14
    s_add_u32 s86, s86, s73
    buffer_load_dwordx4 a[128:131], v18, s[36:39], s86 offen offset:0 sc1
    v_rcp_f32 v240, v240
    v_rcp_f32 v241, v241
    s_waitcnt vmcnt(37)
    s_waitcnt lgkmcnt(2)
    v_mfma_f32_32x32x16_bf16 v[64:79], a[164:167], v[44:47], v[64:79]
    ds_read_b128 v[36:39], v23 offset:16384
    ds_read_b128 v[40:43], v27 offset:16384
    buffer_load_dwordx4 v5, s[20:23], s93 offen offset:3072 lds
    v_rcp_f32 v242, v242
    v_mfma_f32_32x32x16_bf16 v[80:95], a[164:167], v[48:51], v[80:95]
    buffer_load_dwordx4 a[132:135], v18, s[36:39], s86 offen offset:1024 sc1
    v_rcp_f32 v243, v243
    s_waitcnt vmcnt(37)
    s_waitcnt lgkmcnt(2)
    v_mfma_f32_32x32x16_bf16 v[64:79], a[168:171], v[28:31], v[64:79]
    ds_read_b128 v[44:47], v20 offset:24576
    ds_read_b128 v[48:51], v24 offset:24576
    v_mul_f32 v132, v132, v240
    v_mfma_f32_32x32x16_bf16 v[80:95], a[168:171], v[32:35], v[80:95]
    buffer_load_dwordx4 a[136:139], v18, s[36:39], s86 offen offset:2048 sc1
    v_mul_f32 v133, v133, v241
    v_mul_f32 v134, v134, v242
    s_waitcnt vmcnt(36)
    s_waitcnt lgkmcnt(2)
    v_mfma_f32_32x32x16_bf16 v[64:79], a[172:175], v[36:39], v[64:79]
    ds_read_b128 v[28:31], v21 offset:24576
    ds_read_b128 v[32:35], v25 offset:24576
    v_mul_f32 v135, v135, v243
    v_mfma_f32_32x32x16_bf16 v[80:95], a[172:175], v[40:43], v[80:95]
    buffer_load_dwordx4 a[140:143], v18, s[36:39], s86 offen offset:3072 sc1
    v_cvt_pk_bf16_f32 v192, v128, v129
    s_waitcnt vmcnt(36)
    s_waitcnt lgkmcnt(2)
    v_mfma_f32_32x32x16_bf16 v[64:79], a[176:179], v[44:47], v[64:79]
    ds_read_b128 v[36:39], v22 offset:24576
    ds_read_b128 v[40:43], v26 offset:24576
    v_cvt_pk_bf16_f32 v193, v130, v131
    v_mfma_f32_32x32x16_bf16 v[80:95], a[176:179], v[48:51], v[80:95]
    s_add_u32 s86, s86, 4096
    buffer_load_dwordx4 a[144:147], v18, s[36:39], s86 offen offset:0 sc1
    v_cvt_pk_bf16_f32 v194, v132, v133
    v_cvt_pk_bf16_f32 v195, v134, v135
    s_waitcnt vmcnt(35)
    s_waitcnt lgkmcnt(2)
    v_mfma_f32_32x32x16_bf16 v[64:79], a[180:183], v[28:31], v[64:79]
    ds_read_b128 v[44:47], v23 offset:24576
    ds_read_b128 v[48:51], v27 offset:24576
    v_mul_f32 v240, v136, v136
    v_mfma_f32_32x32x16_bf16 v[80:95], a[180:183], v[32:35], v[80:95]
    buffer_load_dwordx4 a[148:151], v18, s[36:39], s86 offen offset:1024 sc1
    v_mul_f32 v241, v137, v137
    s_waitcnt vmcnt(30)
    s_barrier
    s_waitcnt lgkmcnt(2)
    v_mfma_f32_32x32x16_bf16 v[64:79], a[184:187], v[36:39], v[64:79]
    v_add_u32 v20, 32768, v20
    v_add_u32 v21, 32768, v21
    v_add_u32 v22, 32768, v22
    v_add_u32 v23, 32768, v23
    v_add_u32 v24, 32768, v24
    v_add_u32 v25, 32768, v25
    v_add_u32 v26, 32768, v26
    v_add_u32 v27, 32768, v27
    ds_read_b128 v[28:31], v20 offset:0
    ds_read_b128 v[32:35], v24 offset:0
    v_mul_f32 v242, v138, v138
    v_mfma_f32_32x32x16_bf16 v[80:95], a[184:187], v[40:43], v[80:95]
    buffer_load_dwordx4 a[152:155], v18, s[36:39], s86 offen offset:2048 sc1
    v_mul_f32 v243, v139, v139
    v_fma_f32 v240, v240, s56, v17
    v_and_b32 v246, 31, v1
    v_lshlrev_b32 v246, 7, v246
    s_lshl_b32 s98, s45, 12
    s_add_u32 s98, s98, 196608
    buffer_load_dword v247, v246, s[36:39], s98 offen sc1
    s_waitcnt lgkmcnt(2)
    v_mfma_f32_32x32x16_bf16 v[64:79], a[188:191], v[44:47], v[64:79]
    ds_read_b128 v[36:39], v21 offset:0
    ds_read_b128 v[40:43], v25 offset:0
    s_xor_b32 s92, s5, 5
    s_lshl_b32 s92, s92, 9
    s_add_u32 s92, s92, s74
    s_add_u32 s93, s92, 131072
    s_lshl_b32 s94, s72, 1
    s_add_u32 m0, s94, 0
    s_nop 0
    buffer_load_dwordx4 v2, s[20:23], s92 offen offset:0 lds
    v_mfma_f32_32x32x16_bf16 v[80:95], a[188:191], v[48:51], v[80:95]
    buffer_load_dwordx4 a[156:159], v18, s[36:39], s86 offen offset:3072 sc1
    v_fma_f32 v241, v241, s56, v17
    v_fma_f32 v242, v242, s56, v17
    v_fma_f32 v243, v243, s56, v17
    s_waitcnt lgkmcnt(2)
    v_mfma_f32_32x32x16_bf16 v[64:79], a[192:195], v[28:31], v[64:79]
    ds_read_b128 v[44:47], v22 offset:0
    ds_read_b128 v[48:51], v26 offset:0
    buffer_load_dwordx4 v3, s[20:23], s92 offen offset:1024 lds
    v_mfma_f32_32x32x16_bf16 v[80:95], a[192:195], v[32:35], v[80:95]
    s_add_u32 s86, s86, 4096
    buffer_load_dwordx4 a[160:163], v18, s[36:39], s86 offen offset:0 sc1
    v_mul_f32 v240, v136, v240
    v_mul_f32 v241, v137, v241
    s_waitcnt vmcnt(35)
    s_waitcnt lgkmcnt(2)
    v_mfma_f32_32x32x16_bf16 v[64:79], a[196:199], v[36:39], v[64:79]
    ds_read_b128 v[28:31], v23 offset:0
    ds_read_b128 v[32:35], v27 offset:0
    v_mul_f32 v242, v138, v242
    v_mul_f32 v243, v139, v243
    v_mfma_f32_32x32x16_bf16 v[80:95], a[196:199], v[40:43], v[80:95]
    buffer_load_dwordx4 a[164:167], v18, s[36:39], s86 offen offset:1024 sc1
    v_exp_f32 v240, v240
    s_waitcnt vmcnt(35)
    s_waitcnt lgkmcnt(2)
    v_mfma_f32_32x32x16_bf16 v[64:79], a[200:203], v[44:47], v[64:79]
    ds_read_b128 v[36:39], v20 offset:8192
    ds_read_b128 v[40:43], v24 offset:8192
    buffer_load_dwordx4 v4, s[20:23], s92 offen offset:2048 lds
    v_exp_f32 v241, v241
    v_mfma_f32_32x32x16_bf16 v[80:95], a[200:203], v[48:51], v[80:95]
    buffer_load_dwordx4 a[168:171], v18, s[36:39], s86 offen offset:2048 sc1
    v_exp_f32 v242, v242
    s_waitcnt vmcnt(36)
    s_waitcnt lgkmcnt(2)
    v_mfma_f32_32x32x16_bf16 v[64:79], a[204:207], v[28:31], v[64:79]
    ds_read_b128 v[44:47], v21 offset:8192
    ds_read_b128 v[48:51], v25 offset:8192
    buffer_load_dwordx4 v5, s[20:23], s92 offen offset:3072 lds
    v_exp_f32 v243, v243
    v_mfma_f32_32x32x16_bf16 v[80:95], a[204:207], v[32:35], v[80:95]
    buffer_load_dwordx4 a[172:175], v18, s[36:39], s86 offen offset:3072 sc1
    v_add_f32 v240, 1.0, v240
    v_add_f32 v241, 1.0, v241
    s_waitcnt vmcnt(37)
    s_waitcnt lgkmcnt(2)
    v_mfma_f32_32x32x16_bf16 v[64:79], a[208:211], v[36:39], v[64:79]
    ds_read_b128 v[28:31], v22 offset:8192
    ds_read_b128 v[32:35], v26 offset:8192
    v_add_f32 v242, 1.0, v242
    v_mfma_f32_32x32x16_bf16 v[80:95], a[208:211], v[40:43], v[80:95]
    s_add_u32 s86, s86, 4096
    buffer_load_dwordx4 a[176:179], v18, s[36:39], s86 offen offset:0 sc1
    v_add_f32 v243, 1.0, v243
    s_waitcnt vmcnt(37)
    s_waitcnt lgkmcnt(2)
    v_mfma_f32_32x32x16_bf16 v[64:79], a[212:215], v[44:47], v[64:79]
    ds_read_b128 v[36:39], v23 offset:8192
    ds_read_b128 v[40:43], v27 offset:8192
    s_add_u32 m0, m0, 4096
    s_nop 0
    buffer_load_dwordx4 v2, s[20:23], s93 offen offset:0 lds
    v_rcp_f32 v240, v240
    v_mfma_f32_32x32x16_bf16 v[80:95], a[212:215], v[48:51], v[80:95]
    buffer_load_dwordx4 a[180:183], v18, s[36:39], s86 offen offset:1024 sc1
    v_rcp_f32 v241, v241
    v_rcp_f32 v242, v242
    s_waitcnt vmcnt(37)
    s_waitcnt lgkmcnt(2)
    v_mfma_f32_32x32x16_bf16 v[64:79], a[216:219], v[28:31], v[64:79]
    ds_read_b128 v[44:47], v20 offset:16384
    ds_read_b128 v[48:51], v24 offset:16384
    buffer_load_dwordx4 v3, s[20:23], s93 offen offset:1024 lds
    v_rcp_f32 v243, v243
    v_mul_f32 v136, v136, v240
    v_mul_f32 v137, v137, v241
    v_mfma_f32_32x32x16_bf16 v[80:95], a[216:219], v[32:35], v[80:95]
    buffer_load_dwordx4 a[184:187], v18, s[36:39], s86 offen offset:2048 sc1
    s_waitcnt vmcnt(14)
    v_cmp_ne_u32 vcc, s47, v247
    s_mov_b32 s99, 0
    s_nop 3
    s_cbranch_vccz L_fkok_10
L_fk_9:
    s_sleep 2
    buffer_load_dword v247, v246, s[36:39], s98 offen sc1
    s_waitcnt vmcnt(0)
    v_cmp_ne_u32 vcc, s47, v247
    s_add_u32 s99, s99, 1
    s_nop 3
    s_cbranch_vccz L_fkok_10
    s_cmp_lt_u32 s99, 0x40000
    s_cbranch_scc1 L_fk_9
L_fkok_10:
    s_waitcnt lgkmcnt(2)
    v_mfma_f32_32x32x16_bf16 v[64:79], a[220:223], v[36:39], v[64:79]
    ds_read_b128 v[28:31], v21 offset:16384
    ds_read_b128 v[32:35], v25 offset:16384
    v_mul_f32 v138, v138, v242
    v_mul_f32 v139, v139, v243
    v_lshlrev_b32 v236, 2, v1
    s_lshl_b32 s52, s45, 1
    s_add_u32 s52, s52, s63
    s_lshl_b32 s53, s52, 7
    v_mfma_f32_32x32x16_bf16 v[80:95], a[220:223], v[40:43], v[80:95]
    buffer_load_dwordx4 a[188:191], v18, s[36:39], s86 offen offset:3072 sc1
    s_add_u32 s53, s53, 163840
    s_lshl_b32 s52, s52, 11
    s_add_u32 s52, s52, 131072
    buffer_load_dword v208, v236, s[36:39], s52 offen offset:0 sc1
    buffer_load_dword v209, v236, s[36:39], s52 offen offset:256 sc1
    buffer_load_dword v210, v236, s[36:39], s52 offen offset:512 sc1
    buffer_load_dword v211, v236, s[36:39], s52 offen offset:768 sc1
    s_waitcnt lgkmcnt(2)
    v_mfma_f32_32x32x16_bf16 v[64:79], a[224:227], v[44:47], v[64:79]
    ds_read_b128 v[36:39], v22 offset:16384
    ds_read_b128 v[40:43], v26 offset:16384
    buffer_load_dwordx4 v4, s[20:23], s93 offen offset:2048 lds
    v_mul_f32 v240, v140, v140
    v_mul_f32 v241, v141, v141
    v_mul_f32 v242, v142, v142
    buffer_load_dword v212, v236, s[36:39], s52 offen offset:1024 sc1
    buffer_load_dword v213, v236, s[36:39], s52 offen offset:1280 sc1
    buffer_load_dword v214, v236, s[36:39], s52 offen offset:1536 sc1
    v_mfma_f32_32x32x16_bf16 v[80:95], a[224:227], v[48:51], v[80:95]
    s_xor_b32 s86, s5, 5
    s_lshl_b32 s86, s86, 14
    s_add_u32 s86, s86, s73
    buffer_load_dwordx4 a[192:195], v18, s[36:39], s86 offen offset:0 sc1
    buffer_load_dword v215, v236, s[36:39], s52 offen offset:1792 sc1
    v_bfe_u32 v237, v1, 4, 1
    v_xor_b32 v237, 1, v237
    v_lshlrev_b32 v237, 6, v237
    v_lshrrev_b32 v235, 5, v1
    v_lshl_add_u32 v237, v235, 4, v237
    buffer_load_dwordx4 v[216:219], v237, s[36:39], s53 offen sc1
    buffer_load_dwordx4 v[220:223], v237, s[36:39], s53 offen offset:32 sc1
    s_waitcnt lgkmcnt(2)
    v_mfma_f32_32x32x16_bf16 v[64:79], a[228:231], v[28:31], v[64:79]
    ds_read_b128 v[44:47], v23 offset:16384
    ds_read_b128 v[48:51], v27 offset:16384
    buffer_load_dwordx4 v5, s[20:23], s93 offen offset:3072 lds
    v_mfma_f32_32x32x16_bf16 v[80:95], a[228:231], v[32:35], v[80:95]
    buffer_load_dwordx4 a[196:199], v18, s[36:39], s86 offen offset:1024 sc1
    v_mul_f32 v243, v143, v143
    v_fma_f32 v240, v240, s56, v17
    s_waitcnt lgkmcnt(2)
    v_mfma_f32_32x32x16_bf16 v[64:79], a[232:235], v[36:39], v[64:79]
    ds_read_b128 v[28:31], v20 offset:24576
    ds_read_b128 v[32:35], v24 offset:24576
    v_fma_f32 v241, v241, s56, v17
    v_mfma_f32_32x32x16_bf16 v[80:95], a[232:235], v[40:43], v[80:95]
    buffer_load_dwordx4 a[200:203], v18, s[36:39], s86 offen offset:2048 sc1
    v_fma_f32 v242, v242, s56, v17
    v_fma_f32 v243, v243, s56, v17
    s_waitcnt lgkmcnt(2)
    v_mfma_f32_32x32x16_bf16 v[64:79], a[236:239], v[44:47], v[64:79]
    ds_read_b128 v[36:39], v21 offset:24576
    ds_read_b128 v[40:43], v25 offset:24576
    v_mul_f32 v240, v140, v240
    v_mfma_f32_32x32x16_bf16 v[80:95], a[236:239], v[48:51], v[80:95]
    buffer_load_dwordx4 a[204:207], v18, s[36:39], s86 offen offset:3072 sc1
    v_mul_f32 v241, v141, v241
    v_mul_f32 v242, v142, v242
    s_waitcnt lgkmcnt(2)
    v_mfma_f32_32x32x16_bf16 v[64:79], a[240:243], v[28:31], v[64:79]
    ds_read_b128 v[44:47], v22 offset:24576
    ds_read_b128 v[48:51], v26 offset:24576
    v_mul_f32 v243, v143, v243
    v_mfma_f32_32x32x16_bf16 v[80:95], a[240:243], v[32:35], v[80:95]
    s_add_u32 s86, s86, 4096
    buffer_load_dwordx4 a[208:211], v18, s[36:39], s86 offen offset:0 sc1
    v_exp_f32 v240, v240
    s_waitcnt lgkmcnt(2)
    v_mfma_f32_32x32x16_bf16 v[64:79], a[244:247], v[36:39], v[64:79]
    ds_read_b128 v[28:31], v23 offset:24576
    ds_read_b128 v[32:35], v27 offset:24576
    v_exp_f32 v241, v241
    v_mfma_f32_32x32x16_bf16 v[80:95], a[244:247], v[40:43], v[80:95]
    buffer_load_dwordx4 a[212:215], v18, s[36:39], s86 offen offset:1024 sc1
    v_exp_f32 v242, v242
    v_exp_f32 v243, v243
    s_barrier
    s_waitcnt lgkmcnt(2)
    v_mfma_f32_32x32x16_bf16 v[64:79], a[248:251], v[44:47], v[64:79]
    v_add_u32 v20, 32768, v20
    v_add_u32 v21, 32768, v21
    v_add_u32 v22, 32768, v22
    v_add_u32 v23, 32768, v23
    v_add_u32 v24, 32768, v24
    v_add_u32 v25, 32768, v25
    v_add_u32 v26, 32768, v26
    v_add_u32 v27, 32768, v27
    ds_read_b128 v[36:39], v20 offset:0
    ds_read_b128 v[40:43], v24 offset:0
    v_mfma_f32_32x32x16_bf16 v[80:95], a[248:251], v[48:51], v[80:95]
    buffer_load_dwordx4 a[216:219], v18, s[36:39], s86 offen offset:2048 sc1
    v_add_f32 v240, 1.0, v240
    v_add_f32 v241, 1.0, v241
    s_waitcnt lgkmcnt(2)
    v_mfma_f32_32x32x16_bf16 v[64:79], a[252:255], v[28:31], v[64:79]
    ds_read_b128 v[44:47], v21 offset:0
    ds_read_b128 v[48:51], v25 offset:0
    s_xor_b32 s92, s5, 6
    s_lshl_b32 s92, s92, 9
    s_add_u32 s92, s92, s74
    s_add_u32 s93, s92, 131072
    s_lshl_b32 s94, s72, 1
    s_add_u32 m0, s94, 65536
    s_nop 0
    buffer_load_dwordx4 v2, s[20:23], s92 offen offset:0 lds
    v_mfma_f32_32x32x16_bf16 v[80:95], a[252:255], v[32:35], v[80:95]
    buffer_load_dwordx4 a[220:223], v18, s[36:39], s86 offen offset:3072 sc1
    v_add_f32 v242, 1.0, v242
    v_add_f32 v243, 1.0, v243
    v_rcp_f32 v240, v240
    s_waitcnt lgkmcnt(2)
    v_mfma_f32_32x32x16_bf16 v[64:79], a[128:131], v[36:39], v[64:79]
    ds_read_b128 v[28:31], v22 offset:0
    ds_read_b128 v[32:35], v26 offset:0
    buffer_load_dwordx4 v3, s[20:23], s92 offen offset:1024 lds
    v_rcp_f32 v241, v241
    v_mfma_f32_32x32x16_bf16 v[80:95], a[128:131], v[40:43], v[80:95]
    s_add_u32 s86, s86, 4096
    buffer_load_dwordx4 a[224:227], v18, s[36:39], s86 offen offset:0 sc1
    v_rcp_f32 v242, v242
    s_waitcnt lgkmcnt(2)
    v_mfma_f32_32x32x16_bf16 v[64:79], a[132:135], v[44:47], v[64:79]
    ds_read_b128 v[36:39], v23 offset:0
    ds_read_b128 v[40:43], v27 offset:0
    v_rcp_f32 v243, v243
    v_mul_f32 v140, v140, v240
    v_mul_f32 v141, v141, v241
    s_waitcnt vmcnt(11)
    v_cvt_pk_bf16_f32 v224, v208, v209
    v_cvt_pk_bf16_f32 v225, v210, v211
    v_cvt_pk_bf16_f32 v226, v212, v213
    v_mfma_f32_32x32x16_bf16 v[80:95], a[132:135], v[48:51], v[80:95]
    buffer_load_dwordx4 a[228:231], v18, s[36:39], s86 offen offset:1024 sc1
    v_cvt_pk_bf16_f32 v227, v214, v215
    v_cvt_pk_bf16_f32 v228, v216, v217
    v_cvt_pk_bf16_f32 v229, v218, v219
    v_cvt_pk_bf16_f32 v230, v220, v221
    v_cvt_pk_bf16_f32 v231, v222, v223
    v_cndmask_b32 v208, v224, v228, s[60:61]
    v_cndmask_b32 v212, v228, v224, s[60:61]
    v_cndmask_b32 v209, v225, v229, s[60:61]
    s_waitcnt lgkmcnt(2)
    v_mfma_f32_32x32x16_bf16 v[64:79], a[136:139], v[28:31], v[64:79]
    ds_read_b128 v[44:47], v20 offset:8192
    ds_read_b128 v[48:51], v24 offset:8192
    buffer_load_dwordx4 v4, s[20:23], s92 offen offset:2048 lds
    v_mul_f32 v142, v142, v242
    v_mul_f32 v143, v143, v243
    v_cvt_pk_bf16_f32 v196, v136, v137
    v_cndmask_b32 v213, v229, v225, s[60:61]
    v_cndmask_b32 v210, v226, v230, s[60:61]
    v_cndmask_b32 v214, v230, v226, s[60:61]
    v_mfma_f32_32x32x16_bf16 v[80:95], a[136:139], v[32:35], v[80:95]
    buffer_load_dwordx4 a[232:235], v18, s[36:39], s86 offen offset:2048 sc1
    v_cndmask_b32 v211, v227, v231, s[60:61]
    v_cndmask_b32 v215, v231, v227, s[60:61]
    s_nop 0
    v_mfma_f32_32x32x16_bf16 v[96:111], v[208:211], v[52:55], 0
    v_mfma_f32_32x32x16_bf16 v[112:127], v[212:215], v[56:59], 0
    v_bfe_u32 v233, v1, 4, 1
    v_mul_u32_u24 v232, 45056, v233
    v_lshrrev_b32 v233, 5, v1
    v_lshl_add_u32 v232, v233, 8, v232
    s_waitcnt lgkmcnt(2)
    v_mfma_f32_32x32x16_bf16 v[64:79], a[140:143], v[36:39], v[64:79]
    ds_read_b128 v[28:31], v21 offset:8192
    ds_read_b128 v[32:35], v25 offset:8192
    buffer_load_dwordx4 v5, s[20:23], s92 offen offset:3072 lds
    v_cvt_pk_bf16_f32 v197, v138, v139
    v_cvt_pk_bf16_f32 v198, v140, v141
    v_and_b32 v233, 15, v1
    v_mfma_f32_32x32x16_bf16 v[80:95], a[140:143], v[40:43], v[80:95]
    buffer_load_dwordx4 a[236:239], v18, s[36:39], s86 offen offset:3072 sc1
    v_lshl_add_u32 v232, v233, 4, v232
    s_mul_i32 s52, s44, 180224
    s_mul_i32 s53, s62, 90112
    s_add_u32 s52, s52, s53
    s_lshl_b32 s53, s45, 11
    s_add_u32 s52, s52, s53
    s_lshl_b32 s53, s63, 10
    s_add_u32 s52, s52, s53
    s_add_u32 s52, s52, 5242880
    s_waitcnt lgkmcnt(2)
    v_mfma_f32_32x32x16_bf16 v[64:79], a[144:147], v[44:47], v[64:79]
    ds_read_b128 v[36:39], v22 offset:8192
    ds_read_b128 v[40:43], v26 offset:8192
    v_cvt_pk_bf16_f32 v199, v142, v143
    v_mfma_f32_32x32x16_bf16 v[80:95], a[144:147], v[48:51], v[80:95]
    s_add_u32 s86, s86, 4096
    buffer_load_dwordx4 a[240:243], v18, s[36:39], s86 offen offset:0 sc1
    v_mul_f32 v240, v144, v144
    v_mul_f32 v241, v145, v145
    s_waitcnt lgkmcnt(2)
    v_mfma_f32_32x32x16_bf16 v[64:79], a[148:151], v[28:31], v[64:79]
    ds_read_b128 v[44:47], v23 offset:8192
    ds_read_b128 v[48:51], v27 offset:8192
    s_add_u32 m0, m0, 4096
    s_nop 0
    buffer_load_dwordx4 v2, s[20:23], s93 offen offset:0 lds
    v_mul_f32 v242, v146, v146
    v_mul_f32 v243, v147, v147
    v_add_f32 v216, s58, v104
    v_add_f32 v217, s58, v112
    v_mfma_f32_32x32x16_bf16 v[80:95], a[148:151], v[32:35], v[80:95]
    buffer_load_dwordx4 a[244:247], v18, s[36:39], s86 offen offset:1024 sc1
    v_rcp_f32 v216, v216
    v_rcp_f32 v217, v217
    v_mul_f32 v96, v96, v216
    v_mul_f32 v120, v120, v217
    v_mul_f32 v97, v97, v216
    v_mul_f32 v121, v121, v217
    s_waitcnt lgkmcnt(2)
    v_mfma_f32_32x32x16_bf16 v[64:79], a[152:155], v[36:39], v[64:79]
    ds_read_b128 v[28:31], v20 offset:16384
    ds_read_b128 v[32:35], v24 offset:16384
    buffer_load_dwordx4 v3, s[20:23], s93 offen offset:1024 lds
    v_fma_f32 v240, v240, s56, v17
    v_fma_f32 v241, v241, s56, v17
    v_fma_f32 v242, v242, s56, v17
    v_mul_f32 v98, v98, v216
    v_mfma_f32_32x32x16_bf16 v[80:95], a[152:155], v[40:43], v[80:95]
    buffer_load_dwordx4 a[248:251], v18, s[36:39], s86 offen offset:2048 sc1
    v_mul_f32 v122, v122, v217
    v_mul_f32 v99, v99, v216
    v_mul_f32 v123, v123, v217
    v_mul_f32 v100, v100, v216
    v_mul_f32 v124, v124, v217
    v_mul_f32 v101, v101, v216
    s_waitcnt lgkmcnt(2)
    v_mfma_f32_32x32x16_bf16 v[64:79], a[156:159], v[44:47], v[64:79]
    ds_read_b128 v[36:39], v21 offset:16384
    ds_read_b128 v[40:43], v25 offset:16384
    v_fma_f32 v243, v243, s56, v17
    v_mul_f32 v240, v144, v240
    v_mul_f32 v241, v145, v241
    v_mul_f32 v125, v125, v217
    v_mul_f32 v102, v102, v216
    v_mfma_f32_32x32x16_bf16 v[80:95], a[156:159], v[48:51], v[80:95]
    buffer_load_dwordx4 a[252:255], v18, s[36:39], s86 offen offset:3072 sc1
    v_mul_f32 v126, v126, v217
    v_mul_f32 v103, v103, v216
    v_mul_f32 v127, v127, v217
    v_cvt_pk_bf16_f32 v220, v96, v97
    v_cvt_pk_bf16_f32 v221, v98, v99
    v_cvt_pk_bf16_f32 v222, v100, v101
    s_waitcnt lgkmcnt(2)
    v_mfma_f32_32x32x16_bf16 v[64:79], a[160:163], v[28:31], v[64:79]
    ds_read_b128 v[44:47], v22 offset:16384
    ds_read_b128 v[48:51], v26 offset:16384
    buffer_load_dwordx4 v4, s[20:23], s93 offen offset:2048 lds
    v_mul_f32 v242, v146, v242
    v_mul_f32 v243, v147, v243
    v_cvt_pk_bf16_f32 v223, v102, v103
    v_mfma_f32_32x32x16_bf16 v[80:95], a[160:163], v[32:35], v[80:95]
    s_xor_b32 s86, s5, 6
    s_lshl_b32 s86, s86, 14
    s_add_u32 s86, s86, s73
    buffer_load_dwordx4 a[128:131], v18, s[36:39], s86 offen offset:0 sc1
    v_cvt_pk_bf16_f32 v224, v120, v121
    v_cvt_pk_bf16_f32 v225, v122, v123
    v_cvt_pk_bf16_f32 v226, v124, v125
    v_cvt_pk_bf16_f32 v227, v126, v127
    buffer_store_dwordx4 v[220:223], v232, s[36:39], s52 offen sc1
    buffer_store_dwordx4 v[224:227], v232, s[36:39], s52 offen offset:512 sc1
    s_waitcnt lgkmcnt(2)
    v_mfma_f32_32x32x16_bf16 v[64:79], a[164:167], v[36:39], v[64:79]
    ds_read_b128 v[28:31], v23 offset:16384
    ds_read_b128 v[32:35], v27 offset:16384
    buffer_load_dwordx4 v5, s[20:23], s93 offen offset:3072 lds
    v_exp_f32 v240, v240
    v_mfma_f32_32x32x16_bf16 v[80:95], a[164:167], v[40:43], v[80:95]
    buffer_load_dwordx4 a[132:135], v18, s[36:39], s86 offen offset:1024 sc1
    v_exp_f32 v241, v241
    v_exp_f32 v242, v242
    s_waitcnt lgkmcnt(2)
    v_mfma_f32_32x32x16_bf16 v[64:79], a[168:171], v[44:47], v[64:79]
    ds_read_b128 v[36:39], v20 offset:24576
    ds_read_b128 v[40:43], v24 offset:24576
    v_exp_f32 v243, v243
    v_mfma_f32_32x32x16_bf16 v[80:95], a[168:171], v[48:51], v[80:95]
    buffer_load_dwordx4 a[136:139], v18, s[36:39], s86 offen offset:2048 sc1
    v_add_f32 v240, 1.0, v240
    s_waitcnt lgkmcnt(2)
    v_mfma_f32_32x32x16_bf16 v[64:79], a[172:175], v[28:31], v[64:79]
    ds_read_b128 v[44:47], v21 offset:24576
    ds_read_b128 v[48:51], v25 offset:24576
    v_add_f32 v241, 1.0, v241
    v_mfma_f32_32x32x16_bf16 v[80:95], a[172:175], v[32:35], v[80:95]
    buffer_load_dwordx4 a[140:143], v18, s[36:39], s86 offen offset:3072 sc1
    v_add_f32 v242, 1.0, v242
    v_add_f32 v243, 1.0, v243
    s_waitcnt lgkmcnt(2)
    v_mfma_f32_32x32x16_bf16 v[64:79], a[176:179], v[36:39], v[64:79]
    ds_read_b128 v[28:31], v22 offset:24576
    ds_read_b128 v[32:35], v26 offset:24576
    v_rcp_f32 v240, v240
    v_mfma_f32_32x32x16_bf16 v[80:95], a[176:179], v[40:43], v[80:95]
    s_add_u32 s86, s86, 4096
    buffer_load_dwordx4 a[144:147], v18, s[36:39], s86 offen offset:0 sc1
    v_rcp_f32 v241, v241
    s_waitcnt lgkmcnt(2)
    v_mfma_f32_32x32x16_bf16 v[64:79], a[180:183], v[44:47], v[64:79]
    ds_read_b128 v[36:39], v23 offset:24576
    ds_read_b128 v[40:43], v27 offset:24576
    v_rcp_f32 v242, v242
    v_mfma_f32_32x32x16_bf16 v[80:95], a[180:183], v[48:51], v[80:95]
    buffer_load_dwordx4 a[148:151], v18, s[36:39], s86 offen offset:1024 sc1
    v_rcp_f32 v243, v243
    v_mul_f32 v144, v144, v240
    s_waitcnt vmcnt(31)
    s_waitcnt vmcnt(6)
    s_barrier
    s_lshl_b32 s96, s44, 3
    s_add_u32 s96, s96, s45
    s_lshl_b32 s96, s96, 7
    s_add_u32 s96, s96, 40960
    s_cmp_eq_u32 s46, 0
    s_cselect_b32 s96, s96, 0x7f000000
    v_mov_b32 v248, s47
    v_mov_b32 v249, 0
    s_mov_b64 exec, 1
    buffer_store_dword v248, v249, s[36:39], s96 offen sc1
    s_mov_b64 exec, -1
    s_waitcnt lgkmcnt(2)
    v_mfma_f32_32x32x16_bf16 v[64:79], a[184:187], v[28:31], v[64:79]
    v_subrev_u32 v20, 131072, v20
    v_subrev_u32 v21, 131072, v21
    v_subrev_u32 v22, 131072, v22
    v_subrev_u32 v23, 131072, v23
    v_subrev_u32 v24, 131072, v24
    v_subrev_u32 v25, 131072, v25
    v_subrev_u32 v26, 131072, v26
    v_subrev_u32 v27, 131072, v27
    ds_read_b128 v[44:47], v20 offset:0
    ds_read_b128 v[48:51], v24 offset:0
    v_mfma_f32_32x32x16_bf16 v[80:95], a[184:187], v[32:35], v[80:95]
    buffer_load_dwordx4 a[152:155], v18, s[36:39], s86 offen offset:2048 sc1
    v_mul_f32 v145, v145, v241
    v_mul_f32 v146, v146, v242
    v_mul_f32 v147, v147, v243
    s_waitcnt lgkmcnt(2)
    v_mfma_f32_32x32x16_bf16 v[64:79], a[188:191], v[36:39], v[64:79]
    ds_read_b128 v[28:31], v21 offset:0
    ds_read_b128 v[32:35], v25 offset:0
    s_xor_b32 s92, s5, 7
    s_lshl_b32 s92, s92, 9
    s_add_u32 s92, s92, s74
    s_add_u32 s93, s92, 131072
    s_lshl_b32 s94, s72, 1
    s_add_u32 m0, s94, 98304
    s_nop 0
    buffer_load_dwordx4 v2, s[20:23], s92 offen offset:0 lds
    v_mfma_f32_32x32x16_bf16 v[80:95], a[188:191], v[40:43], v[80:95]
    buffer_load_dwordx4 a[156:159], v18, s[36:39], s86 offen offset:3072 sc1
    v_mul_f32 v240, v148, v148
    v_mul_f32 v241, v149, v149
    s_waitcnt lgkmcnt(2)
    v_mfma_f32_32x32x16_bf16 v[64:79], a[192:195], v[44:47], v[64:79]
    ds_read_b128 v[36:39], v22 offset:0
    ds_read_b128 v[40:43], v26 offset:0
    buffer_load_dwordx4 v3, s[20:23], s92 offen offset:1024 lds
    v_mul_f32 v242, v150, v150
    v_mfma_f32_32x32x16_bf16 v[80:95], a[192:195], v[48:51], v[80:95]
    s_add_u32 s86, s86, 4096
    buffer_load_dwordx4 a[160:163], v18, s[36:39], s86 offen offset:0 sc1
    v_mul_f32 v243, v151, v151
    v_fma_f32 v240, v240, s56, v17
    s_waitcnt lgkmcnt(2)
    v_mfma_f32_32x32x16_bf16 v[64:79], a[196:199], v[28:31], v[64:79]
    ds_read_b128 v[44:47], v23 offset:0
    ds_read_b128 v[48:51], v27 offset:0
    v_fma_f32 v241, v241, s56, v17
    v_mfma_f32_32x32x16_bf16 v[80:95], a[196:199], v[32:35], v[80:95]
    buffer_load_dwordx4 a[164:167], v18, s[36:39], s86 offen offset:1024 sc1
    v_fma_f32 v242, v242, s56, v17
    s_waitcnt lgkmcnt(2)
    v_mfma_f32_32x32x16_bf16 v[64:79], a[200:203], v[36:39], v[64:79]
    ds_read_b128 v[28:31], v20 offset:8192
    ds_read_b128 v[32:35], v24 offset:8192
    buffer_load_dwordx4 v4, s[20:23], s92 offen offset:2048 lds
    v_fma_f32 v243, v243, s56, v17
    v_mfma_f32_32x32x16_bf16 v[80:95], a[200:203], v[40:43], v[80:95]
    buffer_load_dwordx4 a[168:171], v18, s[36:39], s86 offen offset:2048 sc1
    v_mul_f32 v240, v148, v240
    v_mul_f32 v241, v149, v241
    s_waitcnt lgkmcnt(2)
    v_mfma_f32_32x32x16_bf16 v[64:79], a[204:207], v[44:47], v[64:79]
    ds_read_b128 v[36:39], v21 offset:8192
    ds_read_b128 v[40:43], v25 offset:8192
    buffer_load_dwordx4 v5, s[20:23], s92 offen offset:3072 lds
    v_mfma_f32_32x32x16_bf16 v[80:95], a[204:207], v[48:51], v[80:95]
    buffer_load_dwordx4 a[172:175], v18, s[36:39], s86 offen offset:3072 sc1
    v_mul_f32 v242, v150, v242
    v_mul_f32 v243, v151, v243
    s_waitcnt lgkmcnt(2)
    v_mfma_f32_32x32x16_bf16 v[64:79], a[208:211], v[28:31], v[64:79]
    ds_read_b128 v[44:47], v22 offset:8192
    ds_read_b128 v[48:51], v26 offset:8192
    v_exp_f32 v240, v240
    v_mfma_f32_32x32x16_bf16 v[80:95], a[208:211], v[32:35], v[80:95]
    s_add_u32 s86, s86, 4096
    buffer_load_dwordx4 a[176:179], v18, s[36:39], s86 offen offset:0 sc1
    v_exp_f32 v241, v241
    v_exp_f32 v242, v242
    s_waitcnt lgkmcnt(2)
    v_mfma_f32_32x32x16_bf16 v[64:79], a[212:215], v[36:39], v[64:79]
    ds_read_b128 v[28:31], v23 offset:8192
    ds_read_b128 v[32:35], v27 offset:8192
    s_add_u32 m0, m0, 4096
    s_nop 0
    buffer_load_dwordx4 v2, s[20:23], s93 offen offset:0 lds
    v_mfma_f32_32x32x16_bf16 v[80:95], a[212:215], v[40:43], v[80:95]
    buffer_load_dwordx4 a[180:183], v18, s[36:39], s86 offen offset:1024 sc1
    v_exp_f32 v243, v243
    v_add_f32 v240, 1.0, v240
    v_add_f32 v241, 1.0, v241
    s_waitcnt lgkmcnt(2)
    v_mfma_f32_32x32x16_bf16 v[64:79], a[216:219], v[44:47], v[64:79]
    ds_read_b128 v[36:39], v20 offset:16384
    ds_read_b128 v[40:43], v24 offset:16384
    buffer_load_dwordx4 v3, s[20:23], s93 offen offset:1024 lds
    v_mfma_f32_32x32x16_bf16 v[80:95], a[216:219], v[48:51], v[80:95]
    buffer_load_dwordx4 a[184:187], v18, s[36:39], s86 offen offset:2048 sc1
    v_add_f32 v242, 1.0, v242
    v_add_f32 v243, 1.0, v243
    s_waitcnt lgkmcnt(2)
    v_mfma_f32_32x32x16_bf16 v[64:79], a[220:223], v[28:31], v[64:79]
    ds_read_b128 v[44:47], v21 offset:16384
    ds_read_b128 v[48:51], v25 offset:16384
    v_rcp_f32 v240, v240
    v_mfma_f32_32x32x16_bf16 v[80:95], a[220:223], v[32:35], v[80:95]
    buffer_load_dwordx4 a[188:191], v18, s[36:39], s86 offen offset:3072 sc1
    v_rcp_f32 v241, v241
    v_rcp_f32 v242, v242
    s_waitcnt lgkmcnt(2)
    v_mfma_f32_32x32x16_bf16 v[64:79], a[224:227], v[36:39], v[64:79]
    ds_read_b128 v[28:31], v22 offset:16384
    ds_read_b128 v[32:35], v26 offset:16384
    buffer_load_dwordx4 v4, s[20:23], s93 offen offset:2048 lds
    v_mfma_f32_32x32x16_bf16 v[80:95], a[224:227], v[40:43], v[80:95]
    s_xor_b32 s86, s5, 7
    s_lshl_b32 s86, s86, 14
    s_add_u32 s86, s86, s73
    buffer_load_dwordx4 a[192:195], v18, s[36:39], s86 offen offset:0 sc1
    v_rcp_f32 v243, v243
    v_mul_f32 v148, v148, v240
    s_waitcnt lgkmcnt(2)
    v_mfma_f32_32x32x16_bf16 v[64:79], a[228:231], v[44:47], v[64:79]
    ds_read_b128 v[36:39], v23 offset:16384
    ds_read_b128 v[40:43], v27 offset:16384
    buffer_load_dwordx4 v5, s[20:23], s93 offen offset:3072 lds
    v_mul_f32 v149, v149, v241
    v_mfma_f32_32x32x16_bf16 v[80:95], a[228:231], v[48:51], v[80:95]
    buffer_load_dwordx4 a[196:199], v18, s[36:39], s86 offen offset:1024 sc1
    v_mul_f32 v150, v150, v242
    v_mul_f32 v151, v151, v243
    s_waitcnt lgkmcnt(2)
    v_mfma_f32_32x32x16_bf16 v[64:79], a[232:235], v[28:31], v[64:79]
    ds_read_b128 v[44:47], v20 offset:24576
    ds_read_b128 v[48:51], v24 offset:24576
    v_cvt_pk_bf16_f32 v200, v144, v145
    v_mfma_f32_32x32x16_bf16 v[80:95], a[232:235], v[32:35], v[80:95]
    buffer_load_dwordx4 a[200:203], v18, s[36:39], s86 offen offset:2048 sc1
    v_cvt_pk_bf16_f32 v201, v146, v147
    v_cvt_pk_bf16_f32 v202, v148, v149
    s_waitcnt lgkmcnt(2)
    v_mfma_f32_32x32x16_bf16 v[64:79], a[236:239], v[36:39], v[64:79]
    ds_read_b128 v[28:31], v21 offset:24576
    ds_read_b128 v[32:35], v25 offset:24576
    v_cvt_pk_bf16_f32 v203, v150, v151
    v_mfma_f32_32x32x16_bf16 v[80:95], a[236:239], v[40:43], v[80:95]
    buffer_load_dwordx4 a[204:207], v18, s[36:39], s86 offen offset:3072 sc1
    v_mul_f32 v240, v152, v152
    s_waitcnt lgkmcnt(2)
    v_mfma_f32_32x32x16_bf16 v[64:79], a[240:243], v[44:47], v[64:79]
    ds_read_b128 v[36:39], v22 offset:24576
    ds_read_b128 v[40:43], v26 offset:24576
    v_mul_f32 v241, v153, v153
    v_mfma_f32_32x32x16_bf16 v[80:95], a[240:243], v[48:51], v[80:95]
    s_add_u32 s86, s86, 4096
    buffer_load_dwordx4 a[208:211], v18, s[36:39], s86 offen offset:0 sc1
    v_mul_f32 v242, v154, v154
    v_mul_f32 v243, v155, v155
    s_waitcnt lgkmcnt(2)
    v_mfma_f32_32x32x16_bf16 v[64:79], a[244:247], v[28:31], v[64:79]
    ds_read_b128 v[44:47], v23 offset:24576
    ds_read_b128 v[48:51], v27 offset:24576
    v_fma_f32 v240, v240, s56, v17
    v_mfma_f32_32x32x16_bf16 v[80:95], a[244:247], v[32:35], v[80:95]
    buffer_load_dwordx4 a[212:215], v18, s[36:39], s86 offen offset:1024 sc1
    v_fma_f32 v241, v241, s56, v17
    s_waitcnt vmcnt(30)
    s_barrier
    s_waitcnt lgkmcnt(2)
    v_mfma_f32_32x32x16_bf16 v[64:79], a[248:251], v[36:39], v[64:79]
    v_add_u32 v20, 65536, v20
    v_add_u32 v21, 65536, v21
    v_add_u32 v22, 65536, v22
    v_add_u32 v23, 65536, v23
    v_add_u32 v24, 65536, v24
    v_add_u32 v25, 65536, v25
    v_add_u32 v26, 65536, v26
    v_add_u32 v27, 65536, v27
    ds_read_b128 v[28:31], v20 offset:0
    ds_read_b128 v[32:35], v24 offset:0
    v_mfma_f32_32x32x16_bf16 v[80:95], a[248:251], v[40:43], v[80:95]
    buffer_load_dwordx4 a[216:219], v18, s[36:39], s86 offen offset:2048 sc1
    v_fma_f32 v242, v242, s56, v17
    v_fma_f32 v243, v243, s56, v17
    v_mul_f32 v240, v152, v240
    s_waitcnt lgkmcnt(2)
    v_mfma_f32_32x32x16_bf16 v[64:79], a[252:255], v[44:47], v[64:79]
    ds_read_b128 v[36:39], v21 offset:0
    ds_read_b128 v[40:43], v25 offset:0
    v_lshrrev_b32 v252, 3, v1
    v_and_b32 v253, 7, v1
    v_and_b32 v254, 6, v252
    v_xor_b32 v253, v253, v254
    v_lshlrev_b32 v252, 10, v252
    v_lshl_add_u32 v9, v253, 4, v252
    v_add_u32 v10, 7168, v9
    v_mfma_f32_32x32x16_bf16 v[80:95], a[252:255], v[48:51], v[80:95]
    buffer_load_dwordx4 a[220:223], v18, s[36:39], s86 offen offset:3072 sc1
    v_add_u32 v11, 14336, v9
    v_add_u32 v12, 21504, v9
    s_lshl_b32 s92, s46, 15
    s_lshl_b32 s94, s45, 7
    s_add_u32 s92, s92, s94
    s_add_u32 s92, s92, 0
    s_lshl_b32 s94, s46, 12
    s_add_u32 m0, s94, 131072
    s_nop 0
    buffer_load_dwordx4 v9, s[24:27], s92 offen offset:0 lds
    v_mul_f32 v241, v153, v241
    v_mul_f32 v242, v154, v242
    s_waitcnt lgkmcnt(2)
    v_mfma_f32_32x32x16_bf16 v[64:79], a[128:131], v[28:31], v[64:79]
    ds_read_b128 v[44:47], v22 offset:0
    ds_read_b128 v[48:51], v26 offset:0
    buffer_load_dwordx4 v10, s[24:27], s92 offen offset:1024 lds
    v_mul_f32 v243, v155, v243
    v_mfma_f32_32x32x16_bf16 v[80:95], a[128:131], v[32:35], v[80:95]
    s_add_u32 s86, s86, 4096
    buffer_load_dwordx4 a[224:227], v18, s[36:39], s86 offen offset:0 sc1
    v_exp_f32 v240, v240
    v_exp_f32 v241, v241
    s_waitcnt vmcnt(34)
    s_waitcnt lgkmcnt(2)
    v_mfma_f32_32x32x16_bf16 v[64:79], a[132:135], v[36:39], v[64:79]
    ds_read_b128 v[28:31], v23 offset:0
    ds_read_b128 v[32:35], v27 offset:0
    v_exp_f32 v242, v242
    v_mfma_f32_32x32x16_bf16 v[80:95], a[132:135], v[40:43], v[80:95]
    buffer_load_dwordx4 a[228:231], v18, s[36:39], s86 offen offset:1024 sc1
    v_exp_f32 v243, v243
    v_add_f32 v240, 1.0, v240
    s_waitcnt vmcnt(34)
    s_waitcnt lgkmcnt(2)
    v_mfma_f32_32x32x16_bf16 v[64:79], a[136:139], v[44:47], v[64:79]
    ds_read_b128 v[36:39], v20 offset:8192
    ds_read_b128 v[40:43], v24 offset:8192
    buffer_load_dwordx4 v11, s[24:27], s92 offen offset:2048 lds
    v_mfma_f32_32x32x16_bf16 v[80:95], a[136:139], v[48:51], v[80:95]
    buffer_load_dwordx4 a[232:235], v18, s[36:39], s86 offen offset:2048 sc1
    v_add_f32 v241, 1.0, v241
    v_add_f32 v242, 1.0, v242
    s_waitcnt vmcnt(35)
    s_waitcnt lgkmcnt(2)
    v_mfma_f32_32x32x16_bf16 v[64:79], a[140:143], v[28:31], v[64:79]
    ds_read_b128 v[44:47], v21 offset:8192
    ds_read_b128 v[48:51], v25 offset:8192
    buffer_load_dwordx4 v12, s[24:27], s92 offen offset:3072 lds
    v_add_f32 v243, 1.0, v243
    v_mfma_f32_32x32x16_bf16 v[80:95], a[140:143], v[32:35], v[80:95]
    buffer_load_dwordx4 a[236:239], v18, s[36:39], s86 offen offset:3072 sc1
    v_rcp_f32 v240, v240
    v_rcp_f32 v241, v241
    s_waitcnt vmcnt(36)
    s_waitcnt lgkmcnt(2)
    v_mfma_f32_32x32x16_bf16 v[64:79], a[144:147], v[36:39], v[64:79]
    ds_read_b128 v[28:31], v22 offset:8192
    ds_read_b128 v[32:35], v26 offset:8192
    v_rcp_f32 v242, v242
    v_mfma_f32_32x32x16_bf16 v[80:95], a[144:147], v[40:43], v[80:95]
    s_add_u32 s86, s86, 4096
    buffer_load_dwordx4 a[240:243], v18, s[36:39], s86 offen offset:0 sc1
    v_rcp_f32 v243, v243
    s_waitcnt vmcnt(36)
    s_waitcnt lgkmcnt(2)
    v_mfma_f32_32x32x16_bf16 v[64:79], a[148:151], v[44:47], v[64:79]
    ds_read_b128 v[36:39], v23 offset:8192
    ds_read_b128 v[40:43], v27 offset:8192
    s_lshl_b32 s92, s46, 15
    s_lshl_b32 s94, s45, 7
    s_add_u32 s92, s92, s94
    s_add_u32 s92, s92, 131072
    s_lshl_b32 s94, s46, 12
    s_add_u32 m0, s94, 147456
    s_nop 0
    buffer_load_dwordx4 v9, s[24:27], s92 offen offset:0 lds
    v_mfma_f32_32x32x16_bf16 v[80:95], a[148:151], v[48:51], v[80:95]
    buffer_load_dwordx4 a[244:247], v18, s[36:39], s86 offen offset:1024 sc1
    v_mul_f32 v152, v152, v240
    v_mul_f32 v153, v153, v241
    v_mul_f32 v154, v154, v242
    s_waitcnt vmcnt(36)
    s_waitcnt lgkmcnt(2)
    v_mfma_f32_32x32x16_bf16 v[64:79], a[152:155], v[28:31], v[64:79]
    ds_read_b128 v[44:47], v20 offset:16384
    ds_read_b128 v[48:51], v24 offset:16384
    buffer_load_dwordx4 v10, s[24:27], s92 offen offset:1024 lds
    v_mul_f32 v155, v155, v243
    v_mfma_f32_32x32x16_bf16 v[80:95], a[152:155], v[32:35], v[80:95]
    buffer_load_dwordx4 a[248:251], v18, s[36:39], s86 offen offset:2048 sc1
    v_mul_f32 v240, v156, v156
    v_mul_f32 v241, v157, v157
    s_waitcnt vmcnt(36)
    s_waitcnt lgkmcnt(2)
    v_mfma_f32_32x32x16_bf16 v[64:79], a[156:159], v[36:39], v[64:79]
    ds_read_b128 v[28:31], v21 offset:16384
    ds_read_b128 v[32:35], v25 offset:16384
    v_mul_f32 v242, v158, v158
    v_mfma_f32_32x32x16_bf16 v[80:95], a[156:159], v[40:43], v[80:95]
    buffer_load_dwordx4 a[252:255], v18, s[36:39], s86 offen offset:3072 sc1
    v_mul_f32 v243, v159, v159
    s_waitcnt vmcnt(35)
    s_waitcnt lgkmcnt(2)
    v_mfma_f32_32x32x16_bf16 v[64:79], a[160:163], v[44:47], v[64:79]
    ds_read_b128 v[36:39], v22 offset:16384
    ds_read_b128 v[40:43], v26 offset:16384
    buffer_load_dwordx4 v11, s[24:27], s92 offen offset:2048 lds
    v_fma_f32 v240, v240, s56, v17
    v_mfma_f32_32x32x16_bf16 v[80:95], a[160:163], v[48:51], v[80:95]
    v_fma_f32 v241, v241, s56, v17
    v_fma_f32 v242, v242, s56, v17
    s_waitcnt vmcnt(35)
    s_waitcnt lgkmcnt(2)
    v_mfma_f32_32x32x16_bf16 v[64:79], a[164:167], v[28:31], v[64:79]
    ds_read_b128 v[44:47], v23 offset:16384
    ds_read_b128 v[48:51], v27 offset:16384
    buffer_load_dwordx4 v12, s[24:27], s92 offen offset:3072 lds
    v_mfma_f32_32x32x16_bf16 v[80:95], a[164:167], v[32:35], v[80:95]
    v_fma_f32 v243, v243, s56, v17
    v_mul_f32 v240, v156, v240
    s_waitcnt vmcnt(34)
    s_waitcnt lgkmcnt(2)
    v_mfma_f32_32x32x16_bf16 v[64:79], a[168:171], v[36:39], v[64:79]
    ds_read_b128 v[28:31], v20 offset:24576
    ds_read_b128 v[32:35], v24 offset:24576
    v_mul_f32 v241, v157, v241
    v_mfma_f32_32x32x16_bf16 v[80:95], a[168:171], v[40:43], v[80:95]
    v_mul_f32 v242, v158, v242
    v_mul_f32 v243, v159, v243
    s_waitcnt vmcnt(32)
    s_waitcnt lgkmcnt(2)
    v_mfma_f32_32x32x16_bf16 v[64:79], a[172:175], v[44:47], v[64:79]
    ds_read_b128 v[36:39], v21 offset:24576
    ds_read_b128 v[40:43], v25 offset:24576
    v_exp_f32 v240, v240
    v_mfma_f32_32x32x16_bf16 v[80:95], a[172:175], v[48:51], v[80:95]
    v_exp_f32 v241, v241
    s_waitcnt vmcnt(31)
    s_waitcnt lgkmcnt(2)
    v_mfma_f32_32x32x16_bf16 v[64:79], a[176:179], v[28:31], v[64:79]
    ds_read_b128 v[44:47], v22 offset:24576
    ds_read_b128 v[48:51], v26 offset:24576
    v_exp_f32 v242, v242
    v_exp_f32 v243, v243
    v_mfma_f32_32x32x16_bf16 v[80:95], a[176:179], v[32:35], v[80:95]
    v_add_f32 v240, 1.0, v240
    v_lshlrev_b32 v62, 4, v1
    buffer_load_dwordx2 v[96:97], v19, s[8:11], s88 offen offset:0
    buffer_load_dwordx2 v[98:99], v19, s[8:11], s88 offen offset:32
    buffer_load_dwordx2 v[100:101], v19, s[8:11], s88 offen offset:64
    s_waitcnt vmcnt(32)
    s_waitcnt lgkmcnt(2)
    v_mfma_f32_32x32x16_bf16 v[64:79], a[180:183], v[36:39], v[64:79]
    ds_read_b128 v[28:31], v23 offset:24576
    ds_read_b128 v[32:35], v27 offset:24576
    v_add_f32 v241, 1.0, v241
    v_add_f32 v242, 1.0, v242
    v_mfma_f32_32x32x16_bf16 v[80:95], a[180:183], v[40:43], v[80:95]
    v_add_f32 v243, 1.0, v243
    buffer_load_dwordx2 v[102:103], v19, s[8:11], s88 offen offset:96
    v_and_b32 v246, 7, v1
    v_lshlrev_b32 v246, 7, v246
    s_waitcnt vmcnt(27)
    s_barrier
    s_waitcnt lgkmcnt(2)
    v_mfma_f32_32x32x16_bf16 v[64:79], a[184:187], v[44:47], v[64:79]
    v_add_u32 v20, 32768, v20
    v_add_u32 v21, 32768, v21
    v_add_u32 v22, 32768, v22
    v_add_u32 v23, 32768, v23
    v_add_u32 v24, 32768, v24
    v_add_u32 v25, 32768, v25
    v_add_u32 v26, 32768, v26
    v_add_u32 v27, 32768, v27
    ds_read_b128 v[36:39], v20 offset:0
    ds_read_b128 v[40:43], v24 offset:0
    v_mfma_f32_32x32x16_bf16 v[80:95], a[184:187], v[48:51], v[80:95]
    v_rcp_f32 v240, v240
    v_rcp_f32 v241, v241
    s_lshl_b32 s96, s44, 10
    s_add_u32 s96, s96, 40960
    buffer_load_dword v247, v246, s[36:39], s96 offen sc1
    s_waitcnt lgkmcnt(2)
    v_mfma_f32_32x32x16_bf16 v[64:79], a[188:191], v[28:31], v[64:79]
    ds_read_b128 v[44:47], v21 offset:0
    ds_read_b128 v[48:51], v25 offset:0
    s_lshl_b32 s92, s46, 15
    s_lshl_b32 s94, s45, 7
    s_add_u32 s92, s92, s94
    s_add_u32 s92, s92, 262144
    s_lshl_b32 s94, s46, 12
    s_add_u32 m0, s94, 0
    s_nop 0
    buffer_load_dwordx4 v9, s[24:27], s92 offen offset:0 lds
    v_mfma_f32_32x32x16_bf16 v[80:95], a[188:191], v[32:35], v[80:95]
    v_rcp_f32 v242, v242
    v_rcp_f32 v243, v243
    v_mul_f32 v156, v156, v240
    s_waitcnt lgkmcnt(2)
    v_mfma_f32_32x32x16_bf16 v[64:79], a[192:195], v[36:39], v[64:79]
    ds_read_b128 v[28:31], v22 offset:0
    ds_read_b128 v[32:35], v26 offset:0
    buffer_load_dwordx4 v10, s[24:27], s92 offen offset:1024 lds
    v_mul_f32 v157, v157, v241
    v_mul_f32 v158, v158, v242
    v_lshlrev_b32 v60, 16, v60
    v_mfma_f32_32x32x16_bf16 v[80:95], a[192:195], v[40:43], v[80:95]
    v_lshlrev_b32 v61, 16, v61
    v_bfe_u32 v209, v1, 4, 1
    v_mul_u32_u24 v208, 45056, v209
    v_lshrrev_b32 v209, 5, v1
    v_lshl_add_u32 v208, v209, 8, v208
    s_waitcnt vmcnt(29)
    s_waitcnt lgkmcnt(2)
    v_mfma_f32_32x32x16_bf16 v[64:79], a[196:199], v[44:47], v[64:79]
    ds_read_b128 v[36:39], v23 offset:0
    ds_read_b128 v[40:43], v27 offset:0
    v_mul_f32 v159, v159, v243
    v_cvt_pk_bf16_f32 v204, v152, v153
    v_cvt_pk_bf16_f32 v205, v154, v155
    v_mfma_f32_32x32x16_bf16 v[80:95], a[196:199], v[48:51], v[80:95]
    v_and_b32 v209, 15, v1
    v_lshl_add_u32 v208, v209, 4, v208
    s_mul_i32 s52, s44, 180224
    s_lshl_b32 s53, s45, 12
    s_add_u32 s52, s52, s53
    s_waitcnt vmcnt(28)
    s_waitcnt lgkmcnt(2)
    v_mfma_f32_32x32x16_bf16 v[64:79], a[200:203], v[28:31], v[64:79]
    ds_read_b128 v[44:47], v20 offset:8192
    ds_read_b128 v[48:51], v24 offset:8192
    buffer_load_dwordx4 v11, s[24:27], s92 offen offset:2048 lds
    v_cvt_pk_bf16_f32 v206, v156, v157
    v_mfma_f32_32x32x16_bf16 v[80:95], a[200:203], v[32:35], v[80:95]
    v_cvt_pk_bf16_f32 v207, v158, v159
    s_lshl_b32 s53, s46, 10
    s_add_u32 s52, s52, s53
    s_add_u32 s52, s52, 5259264
    s_cmp_eq_u32 s45, 7
    s_cselect_b32 s52, 0x7f000000, s52
    s_mul_i32 s53, s62, 90112
    s_waitcnt vmcnt(28)
    s_waitcnt lgkmcnt(2)
    v_mfma_f32_32x32x16_bf16 v[64:79], a[204:207], v[36:39], v[64:79]
    ds_read_b128 v[28:31], v21 offset:8192
    ds_read_b128 v[32:35], v25 offset:8192
    buffer_load_dwordx4 v12, s[24:27], s92 offen offset:3072 lds
    s_add_u32 s54, s52, s53
    v_mfma_f32_32x32x16_bf16 v[80:95], a[204:207], v[40:43], v[80:95]
    s_sub_u32 s55, s52, s53
    s_add_u32 s55, s55, 90112
    s_add_u32 s48, s54, 512
    s_add_u32 s49, s55, 512
    s_waitcnt vmcnt(28)
    s_waitcnt lgkmcnt(2)
    v_mfma_f32_32x32x16_bf16 v[64:79], a[208:211], v[44:47], v[64:79]
    ds_read_b128 v[36:39], v22 offset:8192
    ds_read_b128 v[40:43], v26 offset:8192
    v_mfma_f32_32x32x16_bf16 v[80:95], a[208:211], v[48:51], v[80:95]
    s_waitcnt vmcnt(27)
    s_waitcnt lgkmcnt(2)
    v_mfma_f32_32x32x16_bf16 v[64:79], a[212:215], v[28:31], v[64:79]
    ds_read_b128 v[44:47], v23 offset:8192
    ds_read_b128 v[48:51], v27 offset:8192
    v_mfma_f32_32x32x16_bf16 v[80:95], a[212:215], v[32:35], v[80:95]
    s_lshl_b32 s92, s46, 15
    s_lshl_b32 s94, s45, 7
    s_add_u32 s92, s92, s94
    s_add_u32 s92, s92, 393216
    s_lshl_b32 s94, s46, 12
    s_add_u32 m0, s94, 16384
    s_nop 0
    buffer_load_dwordx4 v9, s[24:27], s92 offen offset:0 lds
    s_waitcnt vmcnt(27)
    s_waitcnt lgkmcnt(2)
    v_mfma_f32_32x32x16_bf16 v[64:79], a[216:219], v[36:39], v[64:79]
    ds_read_b128 v[28:31], v20 offset:16384
    ds_read_b128 v[32:35], v24 offset:16384
    v_mfma_f32_32x32x16_bf16 v[80:95], a[216:219], v[40:43], v[80:95]
    buffer_load_dwordx4 v10, s[24:27], s92 offen offset:1024 lds
    s_waitcnt vmcnt(27)
    s_waitcnt lgkmcnt(2)
    v_mfma_f32_32x32x16_bf16 v[64:79], a[220:223], v[44:47], v[64:79]
    ds_read_b128 v[36:39], v21 offset:16384
    ds_read_b128 v[40:43], v25 offset:16384
    v_mfma_f32_32x32x16_bf16 v[80:95], a[220:223], v[48:51], v[80:95]
    s_waitcnt vmcnt(24)
    s_waitcnt lgkmcnt(2)
    v_mfma_f32_32x32x16_bf16 v[64:79], a[224:227], v[28:31], v[64:79]
    ds_read_b128 v[44:47], v22 offset:16384
    ds_read_b128 v[48:51], v26 offset:16384
    v_mfma_f32_32x32x16_bf16 v[80:95], a[224:227], v[32:35], v[80:95]
    buffer_load_dwordx4 v11, s[24:27], s92 offen offset:2048 lds
    s_waitcnt vmcnt(24)
    s_waitcnt lgkmcnt(2)
    v_mfma_f32_32x32x16_bf16 v[64:79], a[228:231], v[36:39], v[64:79]
    ds_read_b128 v[28:31], v23 offset:16384
    ds_read_b128 v[32:35], v27 offset:16384
    v_mfma_f32_32x32x16_bf16 v[80:95], a[228:231], v[40:43], v[80:95]
    buffer_load_dwordx4 v12, s[24:27], s92 offen offset:3072 lds
    s_waitcnt vmcnt(23)
    s_waitcnt lgkmcnt(2)
    v_mfma_f32_32x32x16_bf16 v[64:79], a[232:235], v[44:47], v[64:79]
    ds_read_b128 v[36:39], v20 offset:24576
    ds_read_b128 v[40:43], v24 offset:24576
    v_mfma_f32_32x32x16_bf16 v[80:95], a[232:235], v[48:51], v[80:95]
    s_waitcnt vmcnt(21)
    s_waitcnt lgkmcnt(2)
    v_mfma_f32_32x32x16_bf16 v[64:79], a[236:239], v[28:31], v[64:79]
    ds_read_b128 v[44:47], v21 offset:24576
    ds_read_b128 v[48:51], v25 offset:24576
    v_mfma_f32_32x32x16_bf16 v[80:95], a[236:239], v[32:35], v[80:95]
    s_waitcnt vmcnt(20)
    s_waitcnt lgkmcnt(2)
    v_mfma_f32_32x32x16_bf16 v[64:79], a[240:243], v[36:39], v[64:79]
    ds_read_b128 v[28:31], v22 offset:24576
    ds_read_b128 v[32:35], v26 offset:24576
    v_mfma_f32_32x32x16_bf16 v[80:95], a[240:243], v[40:43], v[80:95]
    s_waitcnt vmcnt(18)
    s_waitcnt lgkmcnt(2)
    v_mfma_f32_32x32x16_bf16 v[64:79], a[244:247], v[44:47], v[64:79]
    ds_read_b128 v[36:39], v23 offset:24576
    ds_read_b128 v[40:43], v27 offset:24576
    v_mfma_f32_32x32x16_bf16 v[80:95], a[244:247], v[48:51], v[80:95]
    s_waitcnt vmcnt(13)
    s_barrier
    s_waitcnt lgkmcnt(2)
    v_mfma_f32_32x32x16_bf16 v[64:79], a[248:251], v[28:31], v[64:79]
    v_mfma_f32_32x32x16_bf16 v[80:95], a[248:251], v[32:35], v[80:95]
    s_waitcnt lgkmcnt(0)
    v_mfma_f32_32x32x16_bf16 v[64:79], a[252:255], v[36:39], v[64:79]
    s_lshl_b32 s92, s46, 15
    s_lshl_b32 s94, s45, 7
    s_add_u32 s92, s92, s94
    s_add_u32 s92, s92, 0
    s_lshl_b32 s94, s46, 12
    s_add_u32 m0, s94, 65536
    s_nop 0
    buffer_load_dwordx4 v9, s[28:31], s92 offen offset:0 lds
    v_mfma_f32_32x32x16_bf16 v[80:95], a[252:255], v[40:43], v[80:95]
    buffer_load_dwordx4 v10, s[28:31], s92 offen offset:1024 lds
    v_lshlrev_b32 v220, 16, v192
    v_and_b32 v221, 0xffff0000, v192
    v_lshlrev_b32 v222, 16, v193
    v_and_b32 v223, 0xffff0000, v193
    v_lshlrev_b32 v224, 16, v194
    v_and_b32 v225, 0xffff0000, v194
    v_lshlrev_b32 v226, 16, v195
    v_and_b32 v227, 0xffff0000, v195
    v_pk_add_f32 v[64:65], v[64:65], v[60:61] op_sel:[0,0] op_sel_hi:[1,0]
    v_pk_add_f32 v[66:67], v[66:67], v[60:61] op_sel:[0,0] op_sel_hi:[1,0]
    v_pk_add_f32 v[68:69], v[68:69], v[60:61] op_sel:[0,0] op_sel_hi:[1,0]
    v_pk_add_f32 v[70:71], v[70:71], v[60:61] op_sel:[0,0] op_sel_hi:[1,0]
    v_pk_mul_f32 v[64:65], v[64:65], v[220:221]
    v_pk_mul_f32 v[66:67], v[66:67], v[222:223]
    v_pk_mul_f32 v[68:69], v[68:69], v[224:225]
    v_pk_mul_f32 v[70:71], v[70:71], v[226:227]
    v_cvt_pk_bf16_f32 v212, v64, v65
    v_cvt_pk_bf16_f32 v213, v66, v67
    v_cvt_pk_bf16_f32 v214, v68, v69
    v_cvt_pk_bf16_f32 v215, v70, v71
    buffer_store_dwordx4 v[212:215], v208, s[36:39], s54 offen sc1
    v_lshlrev_b32 v220, 16, v196
    v_and_b32 v221, 0xffff0000, v196
    v_lshlrev_b32 v222, 16, v197
    v_and_b32 v223, 0xffff0000, v197
    v_lshlrev_b32 v224, 16, v198
    v_and_b32 v225, 0xffff0000, v198
    v_lshlrev_b32 v226, 16, v199
    v_and_b32 v227, 0xffff0000, v199
    v_pk_add_f32 v[72:73], v[72:73], v[60:61] op_sel:[0,0] op_sel_hi:[1,0]
    v_pk_add_f32 v[74:75], v[74:75], v[60:61] op_sel:[0,0] op_sel_hi:[1,0]
    v_pk_add_f32 v[76:77], v[76:77], v[60:61] op_sel:[0,0] op_sel_hi:[1,0]
    v_pk_add_f32 v[78:79], v[78:79], v[60:61] op_sel:[0,0] op_sel_hi:[1,0]
    v_pk_mul_f32 v[72:73], v[72:73], v[220:221]
    v_pk_mul_f32 v[74:75], v[74:75], v[222:223]
    v_pk_mul_f32 v[76:77], v[76:77], v[224:225]
    v_pk_mul_f32 v[78:79], v[78:79], v[226:227]
    v_cvt_pk_bf16_f32 v216, v72, v73
    v_cvt_pk_bf16_f32 v217, v74, v75
    v_cvt_pk_bf16_f32 v218, v76, v77
    v_cvt_pk_bf16_f32 v219, v78, v79
    buffer_store_dwordx4 v[216:219], v208, s[36:39], s48 offen sc1
    v_lshlrev_b32 v220, 16, v200
    v_and_b32 v221, 0xffff0000, v200
    v_lshlrev_b32 v222, 16, v201
    v_and_b32 v223, 0xffff0000, v201
    v_lshlrev_b32 v224, 16, v202
    v_and_b32 v225, 0xffff0000, v202
    v_lshlrev_b32 v226, 16, v203
    v_and_b32 v227, 0xffff0000, v203
    v_pk_add_f32 v[80:81], v[80:81], v[60:61] op_sel:[0,1] op_sel_hi:[1,1]
    v_pk_add_f32 v[82:83], v[82:83], v[60:61] op_sel:[0,1] op_sel_hi:[1,1]
    v_pk_add_f32 v[84:85], v[84:85], v[60:61] op_sel:[0,1] op_sel_hi:[1,1]
    v_pk_add_f32 v[86:87], v[86:87], v[60:61] op_sel:[0,1] op_sel_hi:[1,1]
    v_pk_mul_f32 v[80:81], v[80:81], v[220:221]
    v_pk_mul_f32 v[82:83], v[82:83], v[222:223]
    v_pk_mul_f32 v[84:85], v[84:85], v[224:225]
    v_pk_mul_f32 v[86:87], v[86:87], v[226:227]
    v_cvt_pk_bf16_f32 v212, v80, v81
    v_cvt_pk_bf16_f32 v213, v82, v83
    v_cvt_pk_bf16_f32 v214, v84, v85
    v_cvt_pk_bf16_f32 v215, v86, v87
    buffer_store_dwordx4 v[212:215], v208, s[36:39], s55 offen sc1
    v_lshlrev_b32 v220, 16, v204
    v_and_b32 v221, 0xffff0000, v204
    v_lshlrev_b32 v222, 16, v205
    v_and_b32 v223, 0xffff0000, v205
    v_lshlrev_b32 v224, 16, v206
    v_and_b32 v225, 0xffff0000, v206
    v_lshlrev_b32 v226, 16, v207
    v_and_b32 v227, 0xffff0000, v207
    v_pk_add_f32 v[88:89], v[88:89], v[60:61] op_sel:[0,1] op_sel_hi:[1,1]
    v_pk_add_f32 v[90:91], v[90:91], v[60:61] op_sel:[0,1] op_sel_hi:[1,1]
    v_pk_add_f32 v[92:93], v[92:93], v[60:61] op_sel:[0,1] op_sel_hi:[1,1]
    v_pk_add_f32 v[94:95], v[94:95], v[60:61] op_sel:[0,1] op_sel_hi:[1,1]
    v_pk_mul_f32 v[88:89], v[88:89], v[220:221]
    v_pk_mul_f32 v[90:91], v[90:91], v[222:223]
    v_pk_mul_f32 v[92:93], v[92:93], v[224:225]
    v_pk_mul_f32 v[94:95], v[94:95], v[226:227]
    v_cvt_pk_bf16_f32 v216, v88, v89
    v_cvt_pk_bf16_f32 v217, v90, v91
    v_cvt_pk_bf16_f32 v218, v92, v93
    v_cvt_pk_bf16_f32 v219, v94, v95
    buffer_store_dwordx4 v[216:219], v208, s[36:39], s49 offen sc1
    s_waitcnt vmcnt(14)
    v_cmp_ne_u32 vcc, s47, v247
    s_mov_b32 s97, 0
    s_nop 3
    s_cbranch_vccz L_s3ok_12
L_s3_11:
    s_sleep 2
    buffer_load_dword v247, v246, s[36:39], s96 offen sc1
    s_waitcnt vmcnt(0)
    v_cmp_ne_u32 vcc, s47, v247
    s_add_u32 s97, s97, 1
    s_nop 3
    s_cbranch_vccz L_s3ok_12
    s_cmp_lt_u32 s97, 0x40000
    s_cbranch_scc1 L_s3_11
L_s3ok_12:
    buffer_load_dwordx4 a[0:3], v62, s[36:39], s87 offen offset:0 sc1
    buffer_load_dwordx4 a[4:7], v62, s[36:39], s87 offen offset:1024 sc1
    buffer_load_dwordx4 a[8:11], v62, s[36:39], s87 offen offset:2048 sc1
    buffer_load_dwordx4 a[12:15], v62, s[36:39], s87 offen offset:3072 sc1
    s_add_u32 s87, s87, 4096
    buffer_load_dwordx4 a[16:19], v62, s[36:39], s87 offen offset:0 sc1
    buffer_load_dwordx4 a[20:23], v62, s[36:39], s87 offen offset:1024 sc1
    buffer_load_dwordx4 a[24:27], v62, s[36:39], s87 offen offset:2048 sc1
    buffer_load_dwordx4 a[28:31], v62, s[36:39], s87 offen offset:3072 sc1
    s_add_u32 s87, s87, 4096
    buffer_load_dwordx4 a[32:35], v62, s[36:39], s87 offen offset:0 sc1
    buffer_load_dwordx4 a[36:39], v62, s[36:39], s87 offen offset:1024 sc1
    buffer_load_dwordx4 a[40:43], v62, s[36:39], s87 offen offset:2048 sc1
    buffer_load_dwordx4 a[44:47], v62, s[36:39], s87 offen offset:3072 sc1
    s_add_u32 s87, s87, 4096
    buffer_load_dwordx4 a[48:51], v62, s[36:39], s87 offen offset:0 sc1
    buffer_load_dwordx4 a[52:55], v62, s[36:39], s87 offen offset:1024 sc1
    buffer_load_dwordx4 a[56:59], v62, s[36:39], s87 offen offset:2048 sc1
    buffer_load_dwordx4 a[60:63], v62, s[36:39], s87 offen offset:3072 sc1
    v_lshrrev_b32 v228, 5, v1
    v_bfe_u32 v229, v1, 4, 1
    v_bfe_u32 v230, v1, 2, 2
    v_lshlrev_b32 v231, 4, v228
    v_lshl_add_u32 v231, v229, 2, v231
    v_add_u32 v231, v231, v230
    v_lshlrev_b32 v231, 7, v231
    v_and_b32 v232, 3, v1
    v_lshl_add_u32 v231, v232, 3, v231
    v_add_u32 v231, 131072, v231
    v_lshrrev_b32 v230, 1, v230
    v_lshl_add_u32 v230, v229, 1, v230
    v_xor_b32 v232, 0, v230
    v_lshl_add_u32 v20, v232, 5, v231
    v_xor_b32 v232, 1, v230
    v_lshl_add_u32 v21, v232, 5, v231
    v_xor_b32 v232, 2, v230
    v_lshl_add_u32 v22, v232, 5, v231
    v_xor_b32 v232, 3, v230
    v_lshl_add_u32 v23, v232, 5, v231
    ds_read_b64_tr_b16 v[128:129], v20 offset:0
    ds_read_b64_tr_b16 v[130:131], v20 offset:1024
    ds_read_b64_tr_b16 v[132:133], v21 offset:0
    ds_read_b64_tr_b16 v[134:135], v21 offset:1024
    ds_read_b64_tr_b16 v[136:137], v22 offset:0
    ds_read_b64_tr_b16 v[138:139], v22 offset:1024
    ds_read_b64_tr_b16 v[140:141], v23 offset:0
    ds_read_b64_tr_b16 v[142:143], v23 offset:1024
    ds_read_b64_tr_b16 v[144:145], v20 offset:4096
    ds_read_b64_tr_b16 v[146:147], v20 offset:5120
    ds_read_b64_tr_b16 v[148:149], v21 offset:4096
    ds_read_b64_tr_b16 v[150:151], v21 offset:5120
    ds_read_b64_tr_b16 v[152:153], v22 offset:4096
    ds_read_b64_tr_b16 v[154:155], v22 offset:5120
    ds_read_b64_tr_b16 v[156:157], v23 offset:4096
    ds_read_b64_tr_b16 v[158:159], v23 offset:5120
    v_and_b32 v56, 31, v1
    v_lshlrev_b32 v56, 10, v56
    s_mov_b32 s75, 41856
    buffer_load_dword v57, v56, s[36:39], s75 offen sc1
    s_waitcnt vmcnt(16)
    s_waitcnt lgkmcnt(8)
    v_mfma_f32_16x16x32_bf16 v[64:67], v[128:131], a[0:3], 0
    ds_read_b64_tr_b16 v[160:161], v20 offset:8192
    ds_read_b64_tr_b16 v[162:163], v20 offset:9216
    buffer_load_dwordx4 v11, s[28:31], s92 offen offset:2048 lds
    v_mfma_f32_16x16x32_bf16 v[68:71], v[132:135], a[0:3], 0
    ds_read_b64_tr_b16 v[164:165], v21 offset:8192
    ds_read_b64_tr_b16 v[166:167], v21 offset:9216
    v_mfma_f32_16x16x32_bf16 v[72:75], v[136:139], a[0:3], 0
    ds_read_b64_tr_b16 v[168:169], v22 offset:8192
    ds_read_b64_tr_b16 v[170:171], v22 offset:9216
    buffer_load_dwordx4 v12, s[28:31], s92 offen offset:3072 lds
    v_mfma_f32_16x16x32_bf16 v[76:79], v[140:143], a[0:3], 0
    ds_read_b64_tr_b16 v[172:173], v23 offset:8192
    ds_read_b64_tr_b16 v[174:175], v23 offset:9216
    s_waitcnt vmcnt(17)
    s_waitcnt lgkmcnt(8)
    v_mfma_f32_16x16x32_bf16 v[64:67], v[144:147], a[4:7], v[64:67]
    ds_read_b64_tr_b16 v[128:129], v20 offset:12288
    ds_read_b64_tr_b16 v[130:131], v20 offset:13312
    v_mfma_f32_16x16x32_bf16 v[68:71], v[148:151], a[4:7], v[68:71]
    ds_read_b64_tr_b16 v[132:133], v21 offset:12288
    ds_read_b64_tr_b16 v[134:135], v21 offset:13312
    s_lshl_b32 s92, s46, 15
    s_lshl_b32 s94, s45, 7
    s_add_u32 s92, s92, s94
    s_add_u32 s92, s92, 131072
    s_lshl_b32 s94, s46, 12
    s_add_u32 m0, s94, 81920
    s_nop 0
    buffer_load_dwordx4 v9, s[28:31], s92 offen offset:0 lds
    v_mfma_f32_16x16x32_bf16 v[72:75], v[152:155], a[4:7], v[72:75]
    ds_read_b64_tr_b16 v[136:137], v22 offset:12288
    ds_read_b64_tr_b16 v[138:139], v22 offset:13312
    v_mfma_f32_16x16x32_bf16 v[76:79], v[156:159], a[4:7], v[76:79]
    ds_read_b64_tr_b16 v[140:141], v23 offset:12288
    ds_read_b64_tr_b16 v[142:143], v23 offset:13312
    s_waitcnt vmcnt(17)
    s_waitcnt lgkmcnt(8)
    v_mfma_f32_16x16x32_bf16 v[64:67], v[160:163], a[8:11], v[64:67]
    ds_read_b64_tr_b16 v[144:145], v20 offset:16384
    ds_read_b64_tr_b16 v[146:147], v20 offset:17408
    buffer_load_dwordx4 v10, s[28:31], s92 offen offset:1024 lds
    v_mfma_f32_16x16x32_bf16 v[68:71], v[164:167], a[8:11], v[68:71]
    ds_read_b64_tr_b16 v[148:149], v21 offset:16384
    ds_read_b64_tr_b16 v[150:151], v21 offset:17408
    v_mfma_f32_16x16x32_bf16 v[72:75], v[168:171], a[8:11], v[72:75]
    ds_read_b64_tr_b16 v[152:153], v22 offset:16384
    ds_read_b64_tr_b16 v[154:155], v22 offset:17408
    buffer_load_dwordx4 v11, s[28:31], s92 offen offset:2048 lds
    v_mfma_f32_16x16x32_bf16 v[76:79], v[172:175], a[8:11], v[76:79]
    ds_read_b64_tr_b16 v[156:157], v23 offset:16384
    ds_read_b64_tr_b16 v[158:159], v23 offset:17408
    s_waitcnt vmcnt(18)
    s_waitcnt lgkmcnt(8)
    v_mfma_f32_16x16x32_bf16 v[64:67], v[128:131], a[12:15], v[64:67]
    ds_read_b64_tr_b16 v[160:161], v20 offset:20480
    ds_read_b64_tr_b16 v[162:163], v20 offset:21504
    v_mfma_f32_16x16x32_bf16 v[68:71], v[132:135], a[12:15], v[68:71]
    ds_read_b64_tr_b16 v[164:165], v21 offset:20480
    ds_read_b64_tr_b16 v[166:167], v21 offset:21504
    buffer_load_dwordx4 v12, s[28:31], s92 offen offset:3072 lds
    v_mfma_f32_16x16x32_bf16 v[72:75], v[136:139], a[12:15], v[72:75]
    ds_read_b64_tr_b16 v[168:169], v22 offset:20480
    ds_read_b64_tr_b16 v[170:171], v22 offset:21504
    v_mfma_f32_16x16x32_bf16 v[76:79], v[140:143], a[12:15], v[76:79]
    ds_read_b64_tr_b16 v[172:173], v23 offset:20480
    ds_read_b64_tr_b16 v[174:175], v23 offset:21504
    s_waitcnt vmcnt(18)
    s_waitcnt lgkmcnt(8)
    v_mfma_f32_16x16x32_bf16 v[64:67], v[144:147], a[16:19], v[64:67]
    ds_read_b64_tr_b16 v[128:129], v20 offset:24576
    ds_read_b64_tr_b16 v[130:131], v20 offset:25600
    v_mfma_f32_16x16x32_bf16 v[68:71], v[148:151], a[16:19], v[68:71]
    ds_read_b64_tr_b16 v[132:133], v21 offset:24576
    ds_read_b64_tr_b16 v[134:135], v21 offset:25600
    v_mfma_f32_16x16x32_bf16 v[72:75], v[152:155], a[16:19], v[72:75]
    ds_read_b64_tr_b16 v[136:137], v22 offset:24576
    ds_read_b64_tr_b16 v[138:139], v22 offset:25600
    v_mfma_f32_16x16x32_bf16 v[76:79], v[156:159], a[16:19], v[76:79]
    ds_read_b64_tr_b16 v[140:141], v23 offset:24576
    ds_read_b64_tr_b16 v[142:143], v23 offset:25600
    s_waitcnt vmcnt(17)
    s_waitcnt lgkmcnt(8)
    v_mfma_f32_16x16x32_bf16 v[64:67], v[160:163], a[20:23], v[64:67]
    ds_read_b64_tr_b16 v[144:145], v20 offset:28672
    ds_read_b64_tr_b16 v[146:147], v20 offset:29696
    v_mfma_f32_16x16x32_bf16 v[68:71], v[164:167], a[20:23], v[68:71]
    ds_read_b64_tr_b16 v[148:149], v21 offset:28672
    ds_read_b64_tr_b16 v[150:151], v21 offset:29696
    v_mfma_f32_16x16x32_bf16 v[72:75], v[168:171], a[20:23], v[72:75]
    ds_read_b64_tr_b16 v[152:153], v22 offset:28672
    ds_read_b64_tr_b16 v[154:155], v22 offset:29696
    v_mfma_f32_16x16x32_bf16 v[76:79], v[172:175], a[20:23], v[76:79]
    ds_read_b64_tr_b16 v[156:157], v23 offset:28672
    ds_read_b64_tr_b16 v[158:159], v23 offset:29696
    s_barrier
    s_waitcnt vmcnt(16)
    s_waitcnt lgkmcnt(8)
    v_mfma_f32_16x16x32_bf16 v[64:67], v[128:131], a[24:27], v[64:67]
    v_subrev_u32 v20, 131072, v20
    v_subrev_u32 v21, 131072, v21
    v_subrev_u32 v22, 131072, v22
    v_subrev_u32 v23, 131072, v23
    ds_read_b64_tr_b16 v[160:161], v20 offset:0
    ds_read_b64_tr_b16 v[162:163], v20 offset:1024
    v_mfma_f32_16x16x32_bf16 v[68:71], v[132:135], a[24:27], v[68:71]
    ds_read_b64_tr_b16 v[164:165], v21 offset:0
    ds_read_b64_tr_b16 v[166:167], v21 offset:1024
    v_mfma_f32_16x16x32_bf16 v[72:75], v[136:139], a[24:27], v[72:75]
    ds_read_b64_tr_b16 v[168:169], v22 offset:0
    ds_read_b64_tr_b16 v[170:171], v22 offset:1024
    v_mfma_f32_16x16x32_bf16 v[76:79], v[140:143], a[24:27], v[76:79]
    ds_read_b64_tr_b16 v[172:173], v23 offset:0
    ds_read_b64_tr_b16 v[174:175], v23 offset:1024
    s_waitcnt vmcnt(15)
    s_waitcnt lgkmcnt(8)
    v_mfma_f32_16x16x32_bf16 v[64:67], v[144:147], a[28:31], v[64:67]
    ds_read_b64_tr_b16 v[128:129], v20 offset:4096
    ds_read_b64_tr_b16 v[130:131], v20 offset:5120
    v_mfma_f32_16x16x32_bf16 v[68:71], v[148:151], a[28:31], v[68:71]
    ds_read_b64_tr_b16 v[132:133], v21 offset:4096
    ds_read_b64_tr_b16 v[134:135], v21 offset:5120
    s_lshl_b32 s92, s46, 15
    s_lshl_b32 s94, s45, 7
    s_add_u32 s92, s92, s94
    s_add_u32 s92, s92, 262144
    s_lshl_b32 s94, s46, 12
    s_add_u32 m0, s94, 98304
    s_nop 0
    buffer_load_dwordx4 v9, s[28:31], s92 offen offset:0 lds
    v_mfma_f32_16x16x32_bf16 v[72:75], v[152:155], a[28:31], v[72:75]
    ds_read_b64_tr_b16 v[136:137], v22 offset:4096
    ds_read_b64_tr_b16 v[138:139], v22 offset:5120
    v_mfma_f32_16x16x32_bf16 v[76:79], v[156:159], a[28:31], v[76:79]
    ds_read_b64_tr_b16 v[140:141], v23 offset:4096
    ds_read_b64_tr_b16 v[142:143], v23 offset:5120
    buffer_load_dwordx4 v10, s[28:31], s92 offen offset:1024 lds
    s_waitcnt vmcnt(16)
    s_waitcnt lgkmcnt(8)
    v_mfma_f32_16x16x32_bf16 v[64:67], v[160:163], a[32:35], v[64:67]
    ds_read_b64_tr_b16 v[144:145], v20 offset:8192
    ds_read_b64_tr_b16 v[146:147], v20 offset:9216
    buffer_load_dwordx4 v11, s[28:31], s92 offen offset:2048 lds
    v_mfma_f32_16x16x32_bf16 v[68:71], v[164:167], a[32:35], v[68:71]
    ds_read_b64_tr_b16 v[148:149], v21 offset:8192
    ds_read_b64_tr_b16 v[150:151], v21 offset:9216
    v_mfma_f32_16x16x32_bf16 v[72:75], v[168:171], a[32:35], v[72:75]
    ds_read_b64_tr_b16 v[152:153], v22 offset:8192
    ds_read_b64_tr_b16 v[154:155], v22 offset:9216
    buffer_load_dwordx4 v12, s[28:31], s92 offen offset:3072 lds
    v_mfma_f32_16x16x32_bf16 v[76:79], v[172:175], a[32:35], v[76:79]
    ds_read_b64_tr_b16 v[156:157], v23 offset:8192
    ds_read_b64_tr_b16 v[158:159], v23 offset:9216
    s_waitcnt vmcnt(17)
    s_waitcnt lgkmcnt(8)
    v_mfma_f32_16x16x32_bf16 v[64:67], v[128:131], a[36:39], v[64:67]
    ds_read_b64_tr_b16 v[160:161], v20 offset:12288
    ds_read_b64_tr_b16 v[162:163], v20 offset:13312
    v_mfma_f32_16x16x32_bf16 v[68:71], v[132:135], a[36:39], v[68:71]
    ds_read_b64_tr_b16 v[164:165], v21 offset:12288
    ds_read_b64_tr_b16 v[166:167], v21 offset:13312
    s_lshl_b32 s92, s46, 15
    s_lshl_b32 s94, s45, 7
    s_add_u32 s92, s92, s94
    s_add_u32 s92, s92, 393216
    s_lshl_b32 s94, s46, 12
    s_add_u32 m0, s94, 114688
    s_nop 0
    buffer_load_dwordx4 v9, s[28:31], s92 offen offset:0 lds
    v_mfma_f32_16x16x32_bf16 v[72:75], v[136:139], a[36:39], v[72:75]
    ds_read_b64_tr_b16 v[168:169], v22 offset:12288
    ds_read_b64_tr_b16 v[170:171], v22 offset:13312
    v_mfma_f32_16x16x32_bf16 v[76:79], v[140:143], a[36:39], v[76:79]
    ds_read_b64_tr_b16 v[172:173], v23 offset:12288
    ds_read_b64_tr_b16 v[174:175], v23 offset:13312
    s_waitcnt vmcnt(17)
    s_waitcnt lgkmcnt(8)
    v_mfma_f32_16x16x32_bf16 v[64:67], v[144:147], a[40:43], v[64:67]
    ds_read_b64_tr_b16 v[128:129], v20 offset:16384
    ds_read_b64_tr_b16 v[130:131], v20 offset:17408
    buffer_load_dwordx4 v10, s[28:31], s92 offen offset:1024 lds
    v_mfma_f32_16x16x32_bf16 v[68:71], v[148:151], a[40:43], v[68:71]
    ds_read_b64_tr_b16 v[132:133], v21 offset:16384
    ds_read_b64_tr_b16 v[134:135], v21 offset:17408
    v_mfma_f32_16x16x32_bf16 v[72:75], v[152:155], a[40:43], v[72:75]
    ds_read_b64_tr_b16 v[136:137], v22 offset:16384
    ds_read_b64_tr_b16 v[138:139], v22 offset:17408
    buffer_load_dwordx4 v11, s[28:31], s92 offen offset:2048 lds
    v_mfma_f32_16x16x32_bf16 v[76:79], v[156:159], a[40:43], v[76:79]
    ds_read_b64_tr_b16 v[140:141], v23 offset:16384
    ds_read_b64_tr_b16 v[142:143], v23 offset:17408
    s_waitcnt vmcnt(18)
    s_waitcnt lgkmcnt(8)
    v_mfma_f32_16x16x32_bf16 v[64:67], v[160:163], a[44:47], v[64:67]
    ds_read_b64_tr_b16 v[144:145], v20 offset:20480
    ds_read_b64_tr_b16 v[146:147], v20 offset:21504
    v_mfma_f32_16x16x32_bf16 v[68:71], v[164:167], a[44:47], v[68:71]
    ds_read_b64_tr_b16 v[148:149], v21 offset:20480
    ds_read_b64_tr_b16 v[150:151], v21 offset:21504
    buffer_load_dwordx4 v12, s[28:31], s92 offen offset:3072 lds
    v_mfma_f32_16x16x32_bf16 v[72:75], v[168:171], a[44:47], v[72:75]
    ds_read_b64_tr_b16 v[152:153], v22 offset:20480
    ds_read_b64_tr_b16 v[154:155], v22 offset:21504
    v_mfma_f32_16x16x32_bf16 v[76:79], v[172:175], a[44:47], v[76:79]
    ds_read_b64_tr_b16 v[156:157], v23 offset:20480
    ds_read_b64_tr_b16 v[158:159], v23 offset:21504
    s_waitcnt vmcnt(18)
    s_waitcnt lgkmcnt(8)
    v_mfma_f32_16x16x32_bf16 v[64:67], v[128:131], a[48:51], v[64:67]
    ds_read_b64_tr_b16 v[160:161], v20 offset:24576
    ds_read_b64_tr_b16 v[162:163], v20 offset:25600
    v_mfma_f32_16x16x32_bf16 v[68:71], v[132:135], a[48:51], v[68:71]
    ds_read_b64_tr_b16 v[164:165], v21 offset:24576
    ds_read_b64_tr_b16 v[166:167], v21 offset:25600
    v_mfma_f32_16x16x32_bf16 v[72:75], v[136:139], a[48:51], v[72:75]
    ds_read_b64_tr_b16 v[168:169], v22 offset:24576
    ds_read_b64_tr_b16 v[170:171], v22 offset:25600
    v_mfma_f32_16x16x32_bf16 v[76:79], v[140:143], a[48:51], v[76:79]
    ds_read_b64_tr_b16 v[172:173], v23 offset:24576
    ds_read_b64_tr_b16 v[174:175], v23 offset:25600
    s_waitcnt vmcnt(17)
    s_waitcnt lgkmcnt(8)
    v_mfma_f32_16x16x32_bf16 v[64:67], v[144:147], a[52:55], v[64:67]
    ds_read_b64_tr_b16 v[128:129], v20 offset:28672
    ds_read_b64_tr_b16 v[130:131], v20 offset:29696
    v_mfma_f32_16x16x32_bf16 v[68:71], v[148:151], a[52:55], v[68:71]
    ds_read_b64_tr_b16 v[132:133], v21 offset:28672
    ds_read_b64_tr_b16 v[134:135], v21 offset:29696
    v_mfma_f32_16x16x32_bf16 v[72:75], v[152:155], a[52:55], v[72:75]
    ds_read_b64_tr_b16 v[136:137], v22 offset:28672
    ds_read_b64_tr_b16 v[138:139], v22 offset:29696
    v_mfma_f32_16x16x32_bf16 v[76:79], v[156:159], a[52:55], v[76:79]
    ds_read_b64_tr_b16 v[140:141], v23 offset:28672
    ds_read_b64_tr_b16 v[142:143], v23 offset:29696
    s_waitcnt vmcnt(8)
    s_barrier
    s_waitcnt lgkmcnt(8)
    v_mfma_f32_16x16x32_bf16 v[64:67], v[160:163], a[56:59], v[64:67]
    s_lshl_b32 s92, s46, 15
    s_lshl_b32 s94, s45, 7
    s_add_u32 s92, s92, s94
    s_add_u32 s92, s92, 524288
    s_lshl_b32 s94, s46, 12
    s_add_u32 m0, s94, 131072
    s_nop 0
    buffer_load_dwordx4 v9, s[28:31], s92 offen offset:0 lds
    v_mfma_f32_16x16x32_bf16 v[68:71], v[164:167], a[56:59], v[68:71]
    buffer_load_dwordx4 v10, s[28:31], s92 offen offset:1024 lds
    buffer_load_dwordx4 v11, s[28:31], s92 offen offset:2048 lds
    buffer_load_dwordx4 v12, s[28:31], s92 offen offset:3072 lds
    v_mfma_f32_16x16x32_bf16 v[72:75], v[168:171], a[56:59], v[72:75]
    s_lshl_b32 s92, s46, 15
    s_lshl_b32 s94, s45, 7
    s_add_u32 s92, s92, s94
    s_add_u32 s92, s92, 655360
    s_lshl_b32 s94, s46, 12
    s_add_u32 m0, s94, 147456
    s_nop 0
    buffer_load_dwordx4 v9, s[28:31], s92 offen offset:0 lds
    v_mfma_f32_16x16x32_bf16 v[76:79], v[172:175], a[56:59], v[76:79]
    buffer_load_dwordx4 v10, s[28:31], s92 offen offset:1024 lds
    buffer_load_dwordx4 v11, s[28:31], s92 offen offset:2048 lds
    buffer_load_dwordx4 v12, s[28:31], s92 offen offset:3072 lds
    s_waitcnt lgkmcnt(0)
    v_mfma_f32_16x16x32_bf16 v[64:67], v[128:131], a[60:63], v[64:67]
    v_mfma_f32_16x16x32_bf16 v[68:71], v[132:135], a[60:63], v[68:71]
    v_mfma_f32_16x16x32_bf16 v[72:75], v[136:139], a[60:63], v[72:75]
    v_mfma_f32_16x16x32_bf16 v[76:79], v[140:143], a[60:63], v[76:79]
    s_barrier
    s_lshl_b32 s92, s46, 15
    s_lshl_b32 s94, s45, 7
    s_add_u32 s92, s92, s94
    s_add_u32 s92, s92, 786432
    s_lshl_b32 s94, s46, 12
    s_add_u32 m0, s94, 0
    s_nop 0
    buffer_load_dwordx4 v9, s[28:31], s92 offen offset:0 lds
    buffer_load_dwordx4 v10, s[28:31], s92 offen offset:1024 lds
    buffer_load_dwordx4 v11, s[28:31], s92 offen offset:2048 lds
    buffer_load_dwordx4 v12, s[28:31], s92 offen offset:3072 lds
    v_lshrrev_b32 v246, 2, v1
    v_min_u32 v246, 6, v246
    v_lshlrev_b32 v246, 12, v246
    v_and_b32 v247, 3, v1
    v_lshl_add_u32 v246, v247, 10, v246
    s_mul_i32 s96, s44, 180224
    s_mul_i32 s97, s46, 45056
    s_add_u32 s96, s96, s97
    s_add_u32 s96, s96, 5259776
    s_mov_b32 s97, 0
L_hp_13:
    buffer_load_dword v247, v246, s[36:39], s96 offen sc1
    s_waitcnt vmcnt(0)
    v_cmp_eq_u32 vcc, -1, v247
    s_add_u32 s97, s97, 1
    s_nop 3
    s_cbranch_vccz L_hpok_14
    s_cmp_lt_u32 s97, 0x40000
    s_cbranch_scc1 L_hp_13
L_hpok_14:
    s_waitcnt vmcnt(0)
    s_barrier
    s_mov_b32 s100, 0
L_hredo:
    s_add_u32 s87, s95, 12288
    v_mov_b32 v249, 0
    s_add_u32 s87, s87, 4096
    buffer_load_dwordx4 a[64:67], v62, s[36:39], s87 offen offset:0 sc1
    buffer_load_dwordx4 a[68:71], v62, s[36:39], s87 offen offset:1024 sc1
    buffer_load_dwordx4 a[72:75], v62, s[36:39], s87 offen offset:2048 sc1
    buffer_load_dwordx4 a[76:79], v62, s[36:39], s87 offen offset:3072 sc1
    s_add_u32 s87, s87, 4096
    buffer_load_dwordx4 a[80:83], v62, s[36:39], s87 offen offset:0 sc1
    buffer_load_dwordx4 a[84:87], v62, s[36:39], s87 offen offset:1024 sc1
    v_lshrrev_b32 v228, 5, v1
    v_bfe_u32 v229, v1, 4, 1
    v_bfe_u32 v230, v1, 2, 2
    v_lshlrev_b32 v231, 4, v228
    v_lshl_add_u32 v231, v229, 2, v231
    v_add_u32 v231, v231, v230
    v_lshlrev_b32 v231, 7, v231
    v_and_b32 v232, 3, v1
    v_lshl_add_u32 v231, v232, 3, v231
    v_add_u32 v231, 65536, v231
    v_lshrrev_b32 v230, 1, v230
    v_lshl_add_u32 v230, v229, 1, v230
    v_xor_b32 v232, 0, v230
    v_lshl_add_u32 v20, v232, 5, v231
    v_xor_b32 v232, 1, v230
    v_lshl_add_u32 v21, v232, 5, v231
    v_xor_b32 v232, 2, v230
    v_lshl_add_u32 v22, v232, 5, v231
    v_xor_b32 v232, 3, v230
    v_lshl_add_u32 v23, v232, 5, v231
    ds_read_b64_tr_b16 v[144:145], v20 offset:0
    ds_read_b64_tr_b16 v[146:147], v20 offset:1024
    ds_read_b64_tr_b16 v[148:149], v21 offset:0
    ds_read_b64_tr_b16 v[150:151], v21 offset:1024
    ds_read_b64_tr_b16 v[152:153], v22 offset:0
    ds_read_b64_tr_b16 v[154:155], v22 offset:1024
    ds_read_b64_tr_b16 v[156:157], v23 offset:0
    ds_read_b64_tr_b16 v[158:159], v23 offset:1024
    ds_read_b64_tr_b16 v[160:161], v20 offset:4096
    ds_read_b64_tr_b16 v[162:163], v20 offset:5120
    ds_read_b64_tr_b16 v[164:165], v21 offset:4096
    ds_read_b64_tr_b16 v[166:167], v21 offset:5120
    ds_read_b64_tr_b16 v[168:169], v22 offset:4096
    ds_read_b64_tr_b16 v[170:171], v22 offset:5120
    ds_read_b64_tr_b16 v[172:173], v23 offset:4096
    ds_read_b64_tr_b16 v[174:175], v23 offset:5120
    s_waitcnt vmcnt(5)
    s_waitcnt lgkmcnt(8)
    v_mfma_f32_16x16x32_bf16 v[80:83], v[144:147], a[64:67], 0
    ds_read_b64_tr_b16 v[128:129], v20 offset:8192
    ds_read_b64_tr_b16 v[130:131], v20 offset:9216
    v_mfma_f32_16x16x32_bf16 v[84:87], v[148:151], a[64:67], 0
    ds_read_b64_tr_b16 v[132:133], v21 offset:8192
    ds_read_b64_tr_b16 v[134:135], v21 offset:9216
    v_mfma_f32_16x16x32_bf16 v[88:91], v[152:155], a[64:67], 0
    ds_read_b64_tr_b16 v[136:137], v22 offset:8192
    ds_read_b64_tr_b16 v[138:139], v22 offset:9216
    v_mfma_f32_16x16x32_bf16 v[92:95], v[156:159], a[64:67], 0
    ds_read_b64_tr_b16 v[140:141], v23 offset:8192
    ds_read_b64_tr_b16 v[142:143], v23 offset:9216
    v_accvgpr_read_b32 v248, a67
    v_max_u32 v249, v249, v248
    buffer_load_dwordx4 a[88:91], v62, s[36:39], s87 offen offset:2048 sc1
    buffer_load_dwordx4 a[92:95], v62, s[36:39], s87 offen offset:3072 sc1
    s_waitcnt vmcnt(6)
    s_waitcnt lgkmcnt(8)
    v_mfma_f32_16x16x32_bf16 v[80:83], v[160:163], a[68:71], v[80:83]
    ds_read_b64_tr_b16 v[144:145], v20 offset:12288
    ds_read_b64_tr_b16 v[146:147], v20 offset:13312
    v_mfma_f32_16x16x32_bf16 v[84:87], v[164:167], a[68:71], v[84:87]
    ds_read_b64_tr_b16 v[148:149], v21 offset:12288
    ds_read_b64_tr_b16 v[150:151], v21 offset:13312
    v_mfma_f32_16x16x32_bf16 v[88:91], v[168:171], a[68:71], v[88:91]
    ds_read_b64_tr_b16 v[152:153], v22 offset:12288
    ds_read_b64_tr_b16 v[154:155], v22 offset:13312
    v_mfma_f32_16x16x32_bf16 v[92:95], v[172:175], a[68:71], v[92:95]
    ds_read_b64_tr_b16 v[156:157], v23 offset:12288
    ds_read_b64_tr_b16 v[158:159], v23 offset:13312
    v_accvgpr_read_b32 v248, a71
    v_max_u32 v249, v249, v248
    s_add_u32 s87, s87, 4096
    buffer_load_dwordx4 a[96:99], v62, s[36:39], s87 offen offset:0 sc1
    buffer_load_dwordx4 a[100:103], v62, s[36:39], s87 offen offset:1024 sc1
    s_waitcnt vmcnt(7)
    s_waitcnt lgkmcnt(8)
    v_mfma_f32_16x16x32_bf16 v[80:83], v[128:131], a[72:75], v[80:83]
    ds_read_b64_tr_b16 v[160:161], v20 offset:16384
    ds_read_b64_tr_b16 v[162:163], v20 offset:17408
    v_mfma_f32_16x16x32_bf16 v[84:87], v[132:135], a[72:75], v[84:87]
    ds_read_b64_tr_b16 v[164:165], v21 offset:16384
    ds_read_b64_tr_b16 v[166:167], v21 offset:17408
    v_mfma_f32_16x16x32_bf16 v[88:91], v[136:139], a[72:75], v[88:91]
    ds_read_b64_tr_b16 v[168:169], v22 offset:16384
    ds_read_b64_tr_b16 v[170:171], v22 offset:17408
    v_mfma_f32_16x16x32_bf16 v[92:95], v[140:143], a[72:75], v[92:95]
    ds_read_b64_tr_b16 v[172:173], v23 offset:16384
    ds_read_b64_tr_b16 v[174:175], v23 offset:17408
    v_accvgpr_read_b32 v248, a75
    v_max_u32 v249, v249, v248
    buffer_load_dwordx4 a[104:107], v62, s[36:39], s87 offen offset:2048 sc1
    buffer_load_dwordx4 a[108:111], v62, s[36:39], s87 offen offset:3072 sc1
    s_waitcnt vmcnt(8)
    s_waitcnt lgkmcnt(8)
    v_mfma_f32_16x16x32_bf16 v[80:83], v[144:147], a[76:79], v[80:83]
    ds_read_b64_tr_b16 v[128:129], v20 offset:20480
    ds_read_b64_tr_b16 v[130:131], v20 offset:21504
    v_mfma_f32_16x16x32_bf16 v[84:87], v[148:151], a[76:79], v[84:87]
    ds_read_b64_tr_b16 v[132:133], v21 offset:20480
    ds_read_b64_tr_b16 v[134:135], v21 offset:21504
    v_mfma_f32_16x16x32_bf16 v[88:91], v[152:155], a[76:79], v[88:91]
    ds_read_b64_tr_b16 v[136:137], v22 offset:20480
    ds_read_b64_tr_b16 v[138:139], v22 offset:21504
    v_mfma_f32_16x16x32_bf16 v[92:95], v[156:159], a[76:79], v[92:95]
    ds_read_b64_tr_b16 v[140:141], v23 offset:20480
    ds_read_b64_tr_b16 v[142:143], v23 offset:21504
    v_accvgpr_read_b32 v248, a79
    v_max_u32 v249, v249, v248
    s_add_u32 s87, s87, 4096
    buffer_load_dwordx4 a[112:115], v62, s[36:39], s87 offen offset:0 sc1
    buffer_load_dwordx4 a[116:119], v62, s[36:39], s87 offen offset:1024 sc1
    s_waitcnt vmcnt(9)
    s_waitcnt lgkmcnt(8)
    v_mfma_f32_16x16x32_bf16 v[80:83], v[160:163], a[80:83], v[80:83]
    ds_read_b64_tr_b16 v[144:145], v20 offset:24576
    ds_read_b64_tr_b16 v[146:147], v20 offset:25600
    v_mfma_f32_16x16x32_bf16 v[84:87], v[164:167], a[80:83], v[84:87]
    ds_read_b64_tr_b16 v[148:149], v21 offset:24576
    ds_read_b64_tr_b16 v[150:151], v21 offset:25600
    v_mfma_f32_16x16x32_bf16 v[88:91], v[168:171], a[80:83], v[88:91]
    ds_read_b64_tr_b16 v[152:153], v22 offset:24576
    ds_read_b64_tr_b16 v[154:155], v22 offset:25600
    v_mfma_f32_16x16x32_bf16 v[92:95], v[172:175], a[80:83], v[92:95]
    ds_read_b64_tr_b16 v[156:157], v23 offset:24576
    ds_read_b64_tr_b16 v[158:159], v23 offset:25600
    v_accvgpr_read_b32 v248, a83
    v_max_u32 v249, v249, v248
    buffer_load_dwordx4 a[120:123], v62, s[36:39], s87 offen offset:2048 sc1
    buffer_load_dwordx4 a[124:127], v62, s[36:39], s87 offen offset:3072 sc1
    s_waitcnt vmcnt(10)
    s_waitcnt lgkmcnt(8)
    v_mfma_f32_16x16x32_bf16 v[80:83], v[128:131], a[84:87], v[80:83]
    ds_read_b64_tr_b16 v[160:161], v20 offset:28672
    ds_read_b64_tr_b16 v[162:163], v20 offset:29696
    v_mfma_f32_16x16x32_bf16 v[84:87], v[132:135], a[84:87], v[84:87]
    ds_read_b64_tr_b16 v[164:165], v21 offset:28672
    ds_read_b64_tr_b16 v[166:167], v21 offset:29696
    v_mfma_f32_16x16x32_bf16 v[88:91], v[136:139], a[84:87], v[88:91]
    ds_read_b64_tr_b16 v[168:169], v22 offset:28672
    ds_read_b64_tr_b16 v[170:171], v22 offset:29696
    v_mfma_f32_16x16x32_bf16 v[92:95], v[140:143], a[84:87], v[92:95]
    ds_read_b64_tr_b16 v[172:173], v23 offset:28672
    ds_read_b64_tr_b16 v[174:175], v23 offset:29696
    v_accvgpr_read_b32 v248, a87
    v_max_u32 v249, v249, v248
    s_add_u32 s87, s87, 4096
    buffer_load_dwordx4 a[128:131], v62, s[36:39], s87 offen offset:0 sc1
    buffer_load_dwordx4 a[132:135], v62, s[36:39], s87 offen offset:1024 sc1
    s_waitcnt vmcnt(11)
    s_waitcnt lgkmcnt(8)
    v_mfma_f32_16x16x32_bf16 v[80:83], v[144:147], a[88:91], v[80:83]
    v_add_u32 v20, 32768, v20
    v_add_u32 v21, 32768, v21
    v_add_u32 v22, 32768, v22
    v_add_u32 v23, 32768, v23
    ds_read_b64_tr_b16 v[128:129], v20 offset:0
    ds_read_b64_tr_b16 v[130:131], v20 offset:1024
    v_mfma_f32_16x16x32_bf16 v[84:87], v[148:151], a[88:91], v[84:87]
    ds_read_b64_tr_b16 v[132:133], v21 offset:0
    ds_read_b64_tr_b16 v[134:135], v21 offset:1024
    v_mfma_f32_16x16x32_bf16 v[88:91], v[152:155], a[88:91], v[88:91]
    ds_read_b64_tr_b16 v[136:137], v22 offset:0
    ds_read_b64_tr_b16 v[138:139], v22 offset:1024
    v_mfma_f32_16x16x32_bf16 v[92:95], v[156:159], a[88:91], v[92:95]
    ds_read_b64_tr_b16 v[140:141], v23 offset:0
    ds_read_b64_tr_b16 v[142:143], v23 offset:1024
    v_accvgpr_read_b32 v248, a91
    v_max_u32 v249, v249, v248
    buffer_load_dwordx4 a[136:139], v62, s[36:39], s87 offen offset:2048 sc1
    buffer_load_dwordx4 a[140:143], v62, s[36:39], s87 offen offset:3072 sc1
    s_waitcnt vmcnt(12)
    s_waitcnt lgkmcnt(8)
    v_mfma_f32_16x16x32_bf16 v[80:83], v[160:163], a[92:95], v[80:83]
    ds_read_b64_tr_b16 v[144:145], v20 offset:4096
    ds_read_b64_tr_b16 v[146:147], v20 offset:5120
    v_mfma_f32_16x16x32_bf16 v[84:87], v[164:167], a[92:95], v[84:87]
    ds_read_b64_tr_b16 v[148:149], v21 offset:4096
    ds_read_b64_tr_b16 v[150:151], v21 offset:5120
    v_mfma_f32_16x16x32_bf16 v[88:91], v[168:171], a[92:95], v[88:91]
    ds_read_b64_tr_b16 v[152:153], v22 offset:4096
    ds_read_b64_tr_b16 v[154:155], v22 offset:5120
    v_mfma_f32_16x16x32_bf16 v[92:95], v[172:175], a[92:95], v[92:95]
    ds_read_b64_tr_b16 v[156:157], v23 offset:4096
    ds_read_b64_tr_b16 v[158:159], v23 offset:5120
    v_accvgpr_read_b32 v248, a95
    v_max_u32 v249, v249, v248
    s_add_u32 s87, s87, 4096
    buffer_load_dwordx4 a[144:147], v62, s[36:39], s87 offen offset:0 sc1
    buffer_load_dwordx4 a[148:151], v62, s[36:39], s87 offen offset:1024 sc1
    s_waitcnt vmcnt(13)
    s_waitcnt lgkmcnt(8)
    v_mfma_f32_16x16x32_bf16 v[80:83], v[128:131], a[96:99], v[80:83]
    ds_read_b64_tr_b16 v[160:161], v20 offset:8192
    ds_read_b64_tr_b16 v[162:163], v20 offset:9216
    v_mfma_f32_16x16x32_bf16 v[84:87], v[132:135], a[96:99], v[84:87]
    ds_read_b64_tr_b16 v[164:165], v21 offset:8192
    ds_read_b64_tr_b16 v[166:167], v21 offset:9216
    v_mfma_f32_16x16x32_bf16 v[88:91], v[136:139], a[96:99], v[88:91]
    ds_read_b64_tr_b16 v[168:169], v22 offset:8192
    ds_read_b64_tr_b16 v[170:171], v22 offset:9216
    v_mfma_f32_16x16x32_bf16 v[92:95], v[140:143], a[96:99], v[92:95]
    ds_read_b64_tr_b16 v[172:173], v23 offset:8192
    ds_read_b64_tr_b16 v[174:175], v23 offset:9216
    v_accvgpr_read_b32 v248, a99
    v_max_u32 v249, v249, v248
    buffer_load_dwordx4 a[152:155], v62, s[36:39], s87 offen offset:2048 sc1
    buffer_load_dwordx4 a[156:159], v62, s[36:39], s87 offen offset:3072 sc1
    s_waitcnt vmcnt(14)
    s_waitcnt lgkmcnt(8)
    v_mfma_f32_16x16x32_bf16 v[80:83], v[144:147], a[100:103], v[80:83]
    ds_read_b64_tr_b16 v[128:129], v20 offset:12288
    ds_read_b64_tr_b16 v[130:131], v20 offset:13312
    v_mfma_f32_16x16x32_bf16 v[84:87], v[148:151], a[100:103], v[84:87]
    ds_read_b64_tr_b16 v[132:133], v21 offset:12288
    ds_read_b64_tr_b16 v[134:135], v21 offset:13312
    v_mfma_f32_16x16x32_bf16 v[88:91], v[152:155], a[100:103], v[88:91]
    ds_read_b64_tr_b16 v[136:137], v22 offset:12288
    ds_read_b64_tr_b16 v[138:139], v22 offset:13312
    v_mfma_f32_16x16x32_bf16 v[92:95], v[156:159], a[100:103], v[92:95]
    ds_read_b64_tr_b16 v[140:141], v23 offset:12288
    ds_read_b64_tr_b16 v[142:143], v23 offset:13312
    v_accvgpr_read_b32 v248, a103
    v_max_u32 v249, v249, v248
    s_add_u32 s87, s87, 4096
    buffer_load_dwordx4 a[160:163], v62, s[36:39], s87 offen offset:0 sc1
    buffer_load_dwordx4 a[164:167], v62, s[36:39], s87 offen offset:1024 sc1
    s_waitcnt vmcnt(15)
    s_waitcnt lgkmcnt(8)
    v_mfma_f32_16x16x32_bf16 v[80:83], v[160:163], a[104:107], v[80:83]
    ds_read_b64_tr_b16 v[144:145], v20 offset:16384
    ds_read_b64_tr_b16 v[146:147], v20 offset:17408
    v_mfma_f32_16x16x32_bf16 v[84:87], v[164:167], a[104:107], v[84:87]
    ds_read_b64_tr_b16 v[148:149], v21 offset:16384
    ds_read_b64_tr_b16 v[150:151], v21 offset:17408
    v_mfma_f32_16x16x32_bf16 v[88:91], v[168:171], a[104:107], v[88:91]
    ds_read_b64_tr_b16 v[152:153], v22 offset:16384
    ds_read_b64_tr_b16 v[154:155], v22 offset:17408
    v_mfma_f32_16x16x32_bf16 v[92:95], v[172:175], a[104:107], v[92:95]
    ds_read_b64_tr_b16 v[156:157], v23 offset:16384
    ds_read_b64_tr_b16 v[158:159], v23 offset:17408
    v_accvgpr_read_b32 v248, a107
    v_max_u32 v249, v249, v248
    buffer_load_dwordx4 a[168:171], v62, s[36:39], s87 offen offset:2048 sc1
    buffer_load_dwordx4 a[172:175], v62, s[36:39], s87 offen offset:3072 sc1
    s_waitcnt vmcnt(16)
    s_waitcnt lgkmcnt(8)
    v_mfma_f32_16x16x32_bf16 v[80:83], v[128:131], a[108:111], v[80:83]
    ds_read_b64_tr_b16 v[160:161], v20 offset:20480
    ds_read_b64_tr_b16 v[162:163], v20 offset:21504
    v_mfma_f32_16x16x32_bf16 v[84:87], v[132:135], a[108:111], v[84:87]
    ds_read_b64_tr_b16 v[164:165], v21 offset:20480
    ds_read_b64_tr_b16 v[166:167], v21 offset:21504
    v_mfma_f32_16x16x32_bf16 v[88:91], v[136:139], a[108:111], v[88:91]
    ds_read_b64_tr_b16 v[168:169], v22 offset:20480
    ds_read_b64_tr_b16 v[170:171], v22 offset:21504
    v_mfma_f32_16x16x32_bf16 v[92:95], v[140:143], a[108:111], v[92:95]
    ds_read_b64_tr_b16 v[172:173], v23 offset:20480
    ds_read_b64_tr_b16 v[174:175], v23 offset:21504
    v_accvgpr_read_b32 v248, a111
    v_max_u32 v249, v249, v248
    s_waitcnt vmcnt(15)
    s_waitcnt lgkmcnt(8)
    v_mfma_f32_16x16x32_bf16 v[80:83], v[144:147], a[112:115], v[80:83]
    ds_read_b64_tr_b16 v[128:129], v20 offset:24576
    ds_read_b64_tr_b16 v[130:131], v20 offset:25600
    v_mfma_f32_16x16x32_bf16 v[84:87], v[148:151], a[112:115], v[84:87]
    ds_read_b64_tr_b16 v[132:133], v21 offset:24576
    ds_read_b64_tr_b16 v[134:135], v21 offset:25600
    v_mfma_f32_16x16x32_bf16 v[88:91], v[152:155], a[112:115], v[88:91]
    ds_read_b64_tr_b16 v[136:137], v22 offset:24576
    ds_read_b64_tr_b16 v[138:139], v22 offset:25600
    v_mfma_f32_16x16x32_bf16 v[92:95], v[156:159], a[112:115], v[92:95]
    ds_read_b64_tr_b16 v[140:141], v23 offset:24576
    ds_read_b64_tr_b16 v[142:143], v23 offset:25600
    v_accvgpr_read_b32 v248, a115
    v_max_u32 v249, v249, v248
    s_waitcnt vmcnt(14)
    s_waitcnt lgkmcnt(8)
    v_mfma_f32_16x16x32_bf16 v[80:83], v[160:163], a[116:119], v[80:83]
    ds_read_b64_tr_b16 v[144:145], v20 offset:28672
    ds_read_b64_tr_b16 v[146:147], v20 offset:29696
    v_mfma_f32_16x16x32_bf16 v[84:87], v[164:167], a[116:119], v[84:87]
    ds_read_b64_tr_b16 v[148:149], v21 offset:28672
    ds_read_b64_tr_b16 v[150:151], v21 offset:29696
    v_mfma_f32_16x16x32_bf16 v[88:91], v[168:171], a[116:119], v[88:91]
    ds_read_b64_tr_b16 v[152:153], v22 offset:28672
    ds_read_b64_tr_b16 v[154:155], v22 offset:29696
    v_mfma_f32_16x16x32_bf16 v[92:95], v[172:175], a[116:119], v[92:95]
    ds_read_b64_tr_b16 v[156:157], v23 offset:28672
    ds_read_b64_tr_b16 v[158:159], v23 offset:29696
    v_accvgpr_read_b32 v248, a119
    v_max_u32 v249, v249, v248
    s_waitcnt vmcnt(13)
    s_waitcnt lgkmcnt(8)
    v_mfma_f32_16x16x32_bf16 v[80:83], v[128:131], a[120:123], v[80:83]
    v_add_u32 v20, 32768, v20
    v_add_u32 v21, 32768, v21
    v_add_u32 v22, 32768, v22
    v_add_u32 v23, 32768, v23
    ds_read_b64_tr_b16 v[160:161], v20 offset:0
    ds_read_b64_tr_b16 v[162:163], v20 offset:1024
    v_mfma_f32_16x16x32_bf16 v[84:87], v[132:135], a[120:123], v[84:87]
    ds_read_b64_tr_b16 v[164:165], v21 offset:0
    ds_read_b64_tr_b16 v[166:167], v21 offset:1024
    v_mfma_f32_16x16x32_bf16 v[88:91], v[136:139], a[120:123], v[88:91]
    ds_read_b64_tr_b16 v[168:169], v22 offset:0
    ds_read_b64_tr_b16 v[170:171], v22 offset:1024
    v_mfma_f32_16x16x32_bf16 v[92:95], v[140:143], a[120:123], v[92:95]
    ds_read_b64_tr_b16 v[172:173], v23 offset:0
    ds_read_b64_tr_b16 v[174:175], v23 offset:1024
    v_accvgpr_read_b32 v248, a123
    v_max_u32 v249, v249, v248
    s_waitcnt vmcnt(12)
    s_waitcnt lgkmcnt(8)
    v_mfma_f32_16x16x32_bf16 v[80:83], v[144:147], a[124:127], v[80:83]
    ds_read_b64_tr_b16 v[128:129], v20 offset:4096
    ds_read_b64_tr_b16 v[130:131], v20 offset:5120
    v_mfma_f32_16x16x32_bf16 v[84:87], v[148:151], a[124:127], v[84:87]
    ds_read_b64_tr_b16 v[132:133], v21 offset:4096
    ds_read_b64_tr_b16 v[134:135], v21 offset:5120
    v_mfma_f32_16x16x32_bf16 v[88:91], v[152:155], a[124:127], v[88:91]
    ds_read_b64_tr_b16 v[136:137], v22 offset:4096
    ds_read_b64_tr_b16 v[138:139], v22 offset:5120
    v_mfma_f32_16x16x32_bf16 v[92:95], v[156:159], a[124:127], v[92:95]
    ds_read_b64_tr_b16 v[140:141], v23 offset:4096
    ds_read_b64_tr_b16 v[142:143], v23 offset:5120
    v_accvgpr_read_b32 v248, a127
    v_max_u32 v249, v249, v248
    s_waitcnt vmcnt(11)
    s_waitcnt lgkmcnt(8)
    v_mfma_f32_16x16x32_bf16 v[80:83], v[160:163], a[128:131], v[80:83]
    ds_read_b64_tr_b16 v[144:145], v20 offset:8192
    ds_read_b64_tr_b16 v[146:147], v20 offset:9216
    v_mfma_f32_16x16x32_bf16 v[84:87], v[164:167], a[128:131], v[84:87]
    ds_read_b64_tr_b16 v[148:149], v21 offset:8192
    ds_read_b64_tr_b16 v[150:151], v21 offset:9216
    v_mfma_f32_16x16x32_bf16 v[88:91], v[168:171], a[128:131], v[88:91]
    ds_read_b64_tr_b16 v[152:153], v22 offset:8192
    ds_read_b64_tr_b16 v[154:155], v22 offset:9216
    v_mfma_f32_16x16x32_bf16 v[92:95], v[172:175], a[128:131], v[92:95]
    ds_read_b64_tr_b16 v[156:157], v23 offset:8192
    ds_read_b64_tr_b16 v[158:159], v23 offset:9216
    v_accvgpr_read_b32 v248, a131
    v_max_u32 v249, v249, v248
    s_waitcnt vmcnt(10)
    s_waitcnt lgkmcnt(8)
    v_mfma_f32_16x16x32_bf16 v[80:83], v[128:131], a[132:135], v[80:83]
    ds_read_b64_tr_b16 v[160:161], v20 offset:12288
    ds_read_b64_tr_b16 v[162:163], v20 offset:13312
    v_mfma_f32_16x16x32_bf16 v[84:87], v[132:135], a[132:135], v[84:87]
    ds_read_b64_tr_b16 v[164:165], v21 offset:12288
    ds_read_b64_tr_b16 v[166:167], v21 offset:13312
    v_mfma_f32_16x16x32_bf16 v[88:91], v[136:139], a[132:135], v[88:91]
    ds_read_b64_tr_b16 v[168:169], v22 offset:12288
    ds_read_b64_tr_b16 v[170:171], v22 offset:13312
    v_mfma_f32_16x16x32_bf16 v[92:95], v[140:143], a[132:135], v[92:95]
    ds_read_b64_tr_b16 v[172:173], v23 offset:12288
    ds_read_b64_tr_b16 v[174:175], v23 offset:13312
    v_accvgpr_read_b32 v248, a135
    v_max_u32 v249, v249, v248
    s_waitcnt vmcnt(9)
    s_waitcnt lgkmcnt(8)
    v_mfma_f32_16x16x32_bf16 v[80:83], v[144:147], a[136:139], v[80:83]
    ds_read_b64_tr_b16 v[128:129], v20 offset:16384
    ds_read_b64_tr_b16 v[130:131], v20 offset:17408
    v_mfma_f32_16x16x32_bf16 v[84:87], v[148:151], a[136:139], v[84:87]
    ds_read_b64_tr_b16 v[132:133], v21 offset:16384
    ds_read_b64_tr_b16 v[134:135], v21 offset:17408
    v_mfma_f32_16x16x32_bf16 v[88:91], v[152:155], a[136:139], v[88:91]
    ds_read_b64_tr_b16 v[136:137], v22 offset:16384
    ds_read_b64_tr_b16 v[138:139], v22 offset:17408
    v_mfma_f32_16x16x32_bf16 v[92:95], v[156:159], a[136:139], v[92:95]
    ds_read_b64_tr_b16 v[140:141], v23 offset:16384
    ds_read_b64_tr_b16 v[142:143], v23 offset:17408
    v_accvgpr_read_b32 v248, a139
    v_max_u32 v249, v249, v248
    s_waitcnt vmcnt(8)
    s_waitcnt lgkmcnt(8)
    v_mfma_f32_16x16x32_bf16 v[80:83], v[160:163], a[140:143], v[80:83]
    ds_read_b64_tr_b16 v[144:145], v20 offset:20480
    ds_read_b64_tr_b16 v[146:147], v20 offset:21504
    v_mfma_f32_16x16x32_bf16 v[84:87], v[164:167], a[140:143], v[84:87]
    ds_read_b64_tr_b16 v[148:149], v21 offset:20480
    ds_read_b64_tr_b16 v[150:151], v21 offset:21504
    v_mfma_f32_16x16x32_bf16 v[88:91], v[168:171], a[140:143], v[88:91]
    ds_read_b64_tr_b16 v[152:153], v22 offset:20480
    ds_read_b64_tr_b16 v[154:155], v22 offset:21504
    v_mfma_f32_16x16x32_bf16 v[92:95], v[172:175], a[140:143], v[92:95]
    ds_read_b64_tr_b16 v[156:157], v23 offset:20480
    ds_read_b64_tr_b16 v[158:159], v23 offset:21504
    v_accvgpr_read_b32 v248, a143
    v_max_u32 v249, v249, v248
    s_waitcnt vmcnt(7)
    s_waitcnt lgkmcnt(8)
    v_mfma_f32_16x16x32_bf16 v[80:83], v[128:131], a[144:147], v[80:83]
    ds_read_b64_tr_b16 v[160:161], v20 offset:24576
    ds_read_b64_tr_b16 v[162:163], v20 offset:25600
    v_mfma_f32_16x16x32_bf16 v[84:87], v[132:135], a[144:147], v[84:87]
    ds_read_b64_tr_b16 v[164:165], v21 offset:24576
    ds_read_b64_tr_b16 v[166:167], v21 offset:25600
    v_mfma_f32_16x16x32_bf16 v[88:91], v[136:139], a[144:147], v[88:91]
    ds_read_b64_tr_b16 v[168:169], v22 offset:24576
    ds_read_b64_tr_b16 v[170:171], v22 offset:25600
    v_mfma_f32_16x16x32_bf16 v[92:95], v[140:143], a[144:147], v[92:95]
    ds_read_b64_tr_b16 v[172:173], v23 offset:24576
    ds_read_b64_tr_b16 v[174:175], v23 offset:25600
    v_accvgpr_read_b32 v248, a147
    v_max_u32 v249, v249, v248
    s_waitcnt vmcnt(6)
    s_waitcnt lgkmcnt(8)
    v_mfma_f32_16x16x32_bf16 v[80:83], v[144:147], a[148:151], v[80:83]
    ds_read_b64_tr_b16 v[128:129], v20 offset:28672
    ds_read_b64_tr_b16 v[130:131], v20 offset:29696
    v_mfma_f32_16x16x32_bf16 v[84:87], v[148:151], a[148:151], v[84:87]
    ds_read_b64_tr_b16 v[132:133], v21 offset:28672
    ds_read_b64_tr_b16 v[134:135], v21 offset:29696
    v_mfma_f32_16x16x32_bf16 v[88:91], v[152:155], a[148:151], v[88:91]
    ds_read_b64_tr_b16 v[136:137], v22 offset:28672
    ds_read_b64_tr_b16 v[138:139], v22 offset:29696
    v_mfma_f32_16x16x32_bf16 v[92:95], v[156:159], a[148:151], v[92:95]
    ds_read_b64_tr_b16 v[140:141], v23 offset:28672
    ds_read_b64_tr_b16 v[142:143], v23 offset:29696
    v_accvgpr_read_b32 v248, a151
    v_max_u32 v249, v249, v248
    s_waitcnt vmcnt(5)
    s_waitcnt lgkmcnt(8)
    v_mfma_f32_16x16x32_bf16 v[80:83], v[160:163], a[152:155], v[80:83]
    v_subrev_u32 v20, 131072, v20
    v_subrev_u32 v21, 131072, v21
    v_subrev_u32 v22, 131072, v22
    v_subrev_u32 v23, 131072, v23
    ds_read_b64_tr_b16 v[144:145], v20 offset:0
    ds_read_b64_tr_b16 v[146:147], v20 offset:1024
    v_mfma_f32_16x16x32_bf16 v[84:87], v[164:167], a[152:155], v[84:87]
    ds_read_b64_tr_b16 v[148:149], v21 offset:0
    ds_read_b64_tr_b16 v[150:151], v21 offset:1024
    v_mfma_f32_16x16x32_bf16 v[88:91], v[168:171], a[152:155], v[88:91]
    ds_read_b64_tr_b16 v[152:153], v22 offset:0
    ds_read_b64_tr_b16 v[154:155], v22 offset:1024
    v_mfma_f32_16x16x32_bf16 v[92:95], v[172:175], a[152:155], v[92:95]
    ds_read_b64_tr_b16 v[156:157], v23 offset:0
    ds_read_b64_tr_b16 v[158:159], v23 offset:1024
    v_accvgpr_read_b32 v248, a155
    v_max_u32 v249, v249, v248
    s_waitcnt vmcnt(4)
    s_waitcnt lgkmcnt(8)
    v_mfma_f32_16x16x32_bf16 v[80:83], v[128:131], a[156:159], v[80:83]
    ds_read_b64_tr_b16 v[160:161], v20 offset:4096
    ds_read_b64_tr_b16 v[162:163], v20 offset:5120
    v_mfma_f32_16x16x32_bf16 v[84:87], v[132:135], a[156:159], v[84:87]
    ds_read_b64_tr_b16 v[164:165], v21 offset:4096
    ds_read_b64_tr_b16 v[166:167], v21 offset:5120
    v_mfma_f32_16x16x32_bf16 v[88:91], v[136:139], a[156:159], v[88:91]
    ds_read_b64_tr_b16 v[168:169], v22 offset:4096
    ds_read_b64_tr_b16 v[170:171], v22 offset:5120
    v_mfma_f32_16x16x32_bf16 v[92:95], v[140:143], a[156:159], v[92:95]
    ds_read_b64_tr_b16 v[172:173], v23 offset:4096
    ds_read_b64_tr_b16 v[174:175], v23 offset:5120
    v_accvgpr_read_b32 v248, a159
    v_max_u32 v249, v249, v248
    s_waitcnt vmcnt(3)
    s_waitcnt lgkmcnt(8)
    v_mfma_f32_16x16x32_bf16 v[80:83], v[144:147], a[160:163], v[80:83]
    ds_read_b64_tr_b16 v[128:129], v20 offset:8192
    ds_read_b64_tr_b16 v[130:131], v20 offset:9216
    v_mfma_f32_16x16x32_bf16 v[84:87], v[148:151], a[160:163], v[84:87]
    ds_read_b64_tr_b16 v[132:133], v21 offset:8192
    ds_read_b64_tr_b16 v[134:135], v21 offset:9216
    v_mfma_f32_16x16x32_bf16 v[88:91], v[152:155], a[160:163], v[88:91]
    ds_read_b64_tr_b16 v[136:137], v22 offset:8192
    ds_read_b64_tr_b16 v[138:139], v22 offset:9216
    v_mfma_f32_16x16x32_bf16 v[92:95], v[156:159], a[160:163], v[92:95]
    ds_read_b64_tr_b16 v[140:141], v23 offset:8192
    ds_read_b64_tr_b16 v[142:143], v23 offset:9216
    v_accvgpr_read_b32 v248, a163
    v_max_u32 v249, v249, v248
    s_waitcnt vmcnt(2)
    s_waitcnt lgkmcnt(8)
    v_mfma_f32_16x16x32_bf16 v[80:83], v[160:163], a[164:167], v[80:83]
    ds_read_b64_tr_b16 v[144:145], v20 offset:12288
    ds_read_b64_tr_b16 v[146:147], v20 offset:13312
    v_mfma_f32_16x16x32_bf16 v[84:87], v[164:167], a[164:167], v[84:87]
    ds_read_b64_tr_b16 v[148:149], v21 offset:12288
    ds_read_b64_tr_b16 v[150:151], v21 offset:13312
    v_mfma_f32_16x16x32_bf16 v[88:91], v[168:171], a[164:167], v[88:91]
    ds_read_b64_tr_b16 v[152:153], v22 offset:12288
    ds_read_b64_tr_b16 v[154:155], v22 offset:13312
    v_mfma_f32_16x16x32_bf16 v[92:95], v[172:175], a[164:167], v[92:95]
    ds_read_b64_tr_b16 v[156:157], v23 offset:12288
    ds_read_b64_tr_b16 v[158:159], v23 offset:13312
    v_accvgpr_read_b32 v248, a167
    v_max_u32 v249, v249, v248
    s_waitcnt vmcnt(1)
    s_waitcnt lgkmcnt(8)
    v_mfma_f32_16x16x32_bf16 v[80:83], v[128:131], a[168:171], v[80:83]
    v_mfma_f32_16x16x32_bf16 v[84:87], v[132:135], a[168:171], v[84:87]
    v_mfma_f32_16x16x32_bf16 v[88:91], v[136:139], a[168:171], v[88:91]
    v_mfma_f32_16x16x32_bf16 v[92:95], v[140:143], a[168:171], v[92:95]
    v_accvgpr_read_b32 v248, a171
    v_max_u32 v249, v249, v248
    s_waitcnt vmcnt(0)
    s_waitcnt lgkmcnt(0)
    v_mfma_f32_16x16x32_bf16 v[80:83], v[144:147], a[172:175], v[80:83]
    v_mfma_f32_16x16x32_bf16 v[84:87], v[148:151], a[172:175], v[84:87]
    v_mfma_f32_16x16x32_bf16 v[88:91], v[152:155], a[172:175], v[88:91]
    v_mfma_f32_16x16x32_bf16 v[92:95], v[156:159], a[172:175], v[92:95]
    v_accvgpr_read_b32 v248, a175
    v_max_u32 v249, v249, v248
    v_cmp_eq_u32 vcc, -1, v249
    s_add_u32 s100, s100, 1
    s_nop 3
    s_cbranch_vccz L_hdone
    s_cmp_lt_u32 s100, 0x1000
    s_cbranch_scc1 L_hredo
L_hdone:
    v_mov_b32 v240, s57
    v_mov_b32 v241, s57
    v_mov_b32 v242, 1.0
    v_mov_b32 v243, 1.0
    v_pk_mul_f32 v[208:209], v[80:81], v[240:241]
    v_pk_mul_f32 v[210:211], v[82:83], v[240:241]
    v_pk_mul_f32 v[212:213], v[84:85], v[240:241]
    v_pk_mul_f32 v[214:215], v[86:87], v[240:241]
    v_pk_mul_f32 v[216:217], v[88:89], v[240:241]
    v_pk_mul_f32 v[218:219], v[90:91], v[240:241]
    v_pk_mul_f32 v[220:221], v[92:93], v[240:241]
    v_pk_mul_f32 v[222:223], v[94:95], v[240:241]
    v_exp_f32 v208, -v208
    v_exp_f32 v209, -v209
    v_exp_f32 v210, -v210
    v_exp_f32 v211, -v211
    v_exp_f32 v212, -v212
    v_exp_f32 v213, -v213
    v_exp_f32 v214, -v214
    v_exp_f32 v215, -v215
    v_exp_f32 v216, -v216
    v_exp_f32 v217, -v217
    v_exp_f32 v218, -v218
    v_exp_f32 v219, -v219
    v_exp_f32 v220, -v220
    v_exp_f32 v221, -v221
    v_exp_f32 v222, -v222
    v_exp_f32 v223, -v223
    v_pk_mul_f32 v[80:81], v[80:81], v[64:65]
    v_pk_mul_f32 v[82:83], v[82:83], v[66:67]
    v_pk_mul_f32 v[84:85], v[84:85], v[68:69]
    v_pk_mul_f32 v[86:87], v[86:87], v[70:71]
    v_pk_mul_f32 v[88:89], v[88:89], v[72:73]
    v_pk_mul_f32 v[90:91], v[90:91], v[74:75]
    v_pk_mul_f32 v[92:93], v[92:93], v[76:77]
    v_pk_mul_f32 v[94:95], v[94:95], v[78:79]
    v_pk_add_f32 v[208:209], v[208:209], v[242:243]
    v_pk_add_f32 v[210:211], v[210:211], v[242:243]
    v_pk_add_f32 v[212:213], v[212:213], v[242:243]
    v_pk_add_f32 v[214:215], v[214:215], v[242:243]
    v_pk_add_f32 v[216:217], v[216:217], v[242:243]
    v_pk_add_f32 v[218:219], v[218:219], v[242:243]
    v_pk_add_f32 v[220:221], v[220:221], v[242:243]
    v_pk_add_f32 v[222:223], v[222:223], v[242:243]
    v_rcp_f32 v208, v208
    v_rcp_f32 v209, v209
    v_rcp_f32 v210, v210
    v_rcp_f32 v211, v211
    v_rcp_f32 v212, v212
    v_rcp_f32 v213, v213
    v_rcp_f32 v214, v214
    v_rcp_f32 v215, v215
    v_rcp_f32 v216, v216
    v_rcp_f32 v217, v217
    v_rcp_f32 v218, v218
    v_rcp_f32 v219, v219
    v_rcp_f32 v220, v220
    v_rcp_f32 v221, v221
    v_rcp_f32 v222, v222
    v_rcp_f32 v223, v223
    v_lshlrev_b32 v224, 16, v96
    v_and_b32 v225, 0xffff0000, v96
    v_lshlrev_b32 v226, 16, v97
    v_and_b32 v227, 0xffff0000, v97
    v_lshlrev_b32 v228, 16, v98
    v_and_b32 v229, 0xffff0000, v98
    v_lshlrev_b32 v230, 16, v99
    v_and_b32 v231, 0xffff0000, v99
    v_lshlrev_b32 v232, 16, v100
    v_and_b32 v233, 0xffff0000, v100
    v_lshlrev_b32 v234, 16, v101
    v_and_b32 v235, 0xffff0000, v101
    v_lshlrev_b32 v236, 16, v102
    v_and_b32 v237, 0xffff0000, v102
    v_lshlrev_b32 v238, 16, v103
    v_and_b32 v239, 0xffff0000, v103
    v_pk_fma_f32 v[208:209], v[208:209], v[80:81], v[224:225]
    v_pk_fma_f32 v[210:211], v[210:211], v[82:83], v[226:227]
    v_cvt_pk_bf16_f32 v64, v208, v209
    v_cvt_pk_bf16_f32 v65, v210, v211
    buffer_store_dwordx2 v[64:65], v19, s[32:35], s88 offen offset:0
    v_pk_fma_f32 v[212:213], v[212:213], v[84:85], v[228:229]
    v_pk_fma_f32 v[214:215], v[214:215], v[86:87], v[230:231]
    v_cvt_pk_bf16_f32 v66, v212, v213
    v_cvt_pk_bf16_f32 v67, v214, v215
    buffer_store_dwordx2 v[66:67], v19, s[32:35], s88 offen offset:32
    v_pk_fma_f32 v[216:217], v[216:217], v[88:89], v[232:233]
    v_pk_fma_f32 v[218:219], v[218:219], v[90:91], v[234:235]
    v_cvt_pk_bf16_f32 v68, v216, v217
    v_cvt_pk_bf16_f32 v69, v218, v219
    buffer_store_dwordx2 v[68:69], v19, s[32:35], s88 offen offset:64
    v_pk_fma_f32 v[220:221], v[220:221], v[92:93], v[236:237]
    v_pk_fma_f32 v[222:223], v[222:223], v[94:95], v[238:239]
    v_cvt_pk_bf16_f32 v70, v220, v221
    v_cvt_pk_bf16_f32 v71, v222, v223
    buffer_store_dwordx2 v[70:71], v19, s[32:35], s88 offen offset:96
    s_or_b32 s96, s2, s46
    s_cmp_lg_u32 s96, 0
    s_cbranch_scc1 L_noep
    v_cmp_ne_u32 vcc, s47, v57
    s_mov_b32 s97, 0
    s_nop 3
    s_cbranch_vccz L_epok_16
L_ep_15:
    s_sleep 2
    buffer_load_dword v57, v56, s[36:39], s75 offen sc1
    s_waitcnt vmcnt(0)
    v_cmp_ne_u32 vcc, s47, v57
    s_add_u32 s97, s97, 1
    s_nop 3
    s_cbranch_vccz L_epok_16
    s_cmp_lt_u32 s97, 0x40000
    s_cbranch_scc1 L_ep_15
L_epok_16:
    s_mov_b32 s96, 0
    v_mov_b32 v56, s47
    v_mov_b32 v57, 0
    s_mov_b64 exec, 1
    buffer_store_dword v56, v57, s[36:39], s96 offen sc1
    s_mov_b64 exec, -1
L_noep:
    s_waitcnt vmcnt(0)
L_end:
    s_endpgm
.section .rodata,"a"
.p2align 6
.amdhsa_kernel recurrent_scan__linear_attn_block__mixer_gmlp__prompt_kernel
  .amdhsa_next_free_vgpr 512
  .amdhsa_next_free_sgpr 102
  .amdhsa_accum_offset 256
  .amdhsa_group_segment_fixed_size 0
  .amdhsa_kernarg_size 88
  .amdhsa_user_sgpr_count 2
  .amdhsa_user_sgpr_kernarg_segment_ptr 1
  .amdhsa_system_sgpr_workgroup_id_x 1
.end_amdhsa_kernel
```
